```python
import torch

def _softmax(x, axis=-1):
    return torch.softmax(x, dim=axis)
def _gelu(x):
    return torch.nn.functional.gelu(x, approximate="tanh")
def _silu(x):
    return torch.nn.functional.silu(x)
def _sigmoid(x):
    return torch.sigmoid(x)
def _layernorm(x, axis=-1, eps=1e-5):
    m = x.mean(dim=axis, keepdim=True)
    v = x.var(dim=axis, keepdim=True, unbiased=False)
    return (x - m) / torch.sqrt(v + eps)
def _scatter_add(tgt, idx, src, axis=0):
    return tgt.clone().index_add_(axis, idx, src)
def _segment_sum(src, seg, n):
    out = torch.zeros((n,) + src.shape[1:], dtype=src.dtype)
    return out.index_add_(0, seg, src)
def _pad(x, pw):
    flat = tuple(v for pair in reversed(pw) for v in pair)
    return torch.nn.functional.pad(x, flat)

kernel_name = 'gated_mix__sliding_block__linear_attn_block__prompt'

def setup_inputs():

    _w = (lambda a: (lambda t: t.to(torch.bfloat16) if t.is_floating_point() else t)(torch.as_tensor(a)))
    def _A_setup():
        B, S, D = 1, 2048, 448
        return {
            "x": _w((lambda *s: torch.randn(*s, dtype=torch.bfloat16) * 0.05)(B, S, D)),
            "wqkv": _w((lambda *s: torch.randn(*s, dtype=torch.bfloat16) * 1.6)(D, 3 * D)),
            "wo": _w((lambda *s: torch.randn(*s, dtype=torch.bfloat16) * 0.05)(D, D)),
        }
    _A_in = _A_setup()

    def _B_setup():
        B, S, D = 1, 2048, 448
        return {
            "x": _w((lambda *s: torch.randn(*s, dtype=torch.bfloat16) * 0.05)(B, S, D)),
            "wqkv": _w((lambda *s: torch.randn(*s, dtype=torch.bfloat16) * 1.6)(D, 3 * D)),
            "wo": _w((lambda *s: torch.randn(*s, dtype=torch.bfloat16) * 0.8)(D, D)),
        }
    _B_in = _B_setup()

    return {
        "A_x": _A_in["x"],
        "A_wqkv": _A_in["wqkv"],
        "A_wo": _A_in["wo"],
        "B_x": _B_in["x"],
        "B_wqkv": _B_in["wqkv"],
        "B_wo": _B_in["wo"],
        "gate_w": _w((lambda *s: torch.randn(*s, dtype=torch.bfloat16) * 0.05)(448) * 16.0),
    }

def reference(A_x, A_wqkv, A_wo, B_x, B_wqkv, B_wo, gate_w):
    def _A_ref(x, wqkv, wo):
        B, S, D = x.shape
        H = 16; Dh = D // H; W = 256
        qkv = (lambda x, *d: x.permute(*d))((x @ wqkv).reshape(B, S, 3, H, Dh), 2, 0, 3, 1, 4)
        q, k, v = qkv[0], qkv[1], qkv[2]
        scores = torch.einsum("bhqd,bhkd->bhqk", q, k) * (Dh ** -0.5)
        idx = torch.arange(S)
        mask = (idx[:, None] - idx[None, :] >= 0) & (idx[:, None] - idx[None, :] < W)
        scores = torch.where(mask[None, None], scores, -1e9)
        p = _softmax(scores, axis=-1)
        o = torch.einsum("bhqk,bhkd->bhqd", p, v)
        return (lambda x, *d: x.permute(*d))(o, 0, 2, 1, 3).reshape(B, S, D) @ wo

    def _B_ref(x, wqkv, wo):
        B, S, D = x.shape
        H = 16; Dh = D // H
        qkv = (lambda x, *d: x.permute(*d))((x @ wqkv).reshape(B, S, 3, H, Dh), 2, 0, 3, 1, 4)
        q, k, v = qkv[0], qkv[1], qkv[2]
        phi = lambda t: torch.where(t > 0, t + 1, torch.exp(t)) + 1e-6
        pq, pk = phi(q), phi(k)
        kv = torch.einsum("bhsd,bhse->bhde", pk, v)
        z = torch.einsum("bhsd->bhd", pk)
        num = torch.einsum("bhqd,bhde->bhqe", pq, kv)
        den = torch.einsum("bhqd,bhd->bhq", pq, z)[..., None] + 1e-6
        o = num / den
        return (lambda x, *d: x.permute(*d))(o, 0, 2, 1, 3).reshape(B, S, D) @ wo

    x = A_x
    g = _sigmoid((x * gate_w).sum(-1, keepdims=True))
    a = _A_ref(x, A_wqkv, A_wo)
    b = _B_ref(x, B_wqkv, B_wo)
    return g * a + (1 - g) * b
```

```asm
; @launch grid=(256,1,1) block=(512,1,1) lds=163840
.amdgcn_target "amdgcn-amd-amdhsa--gfx950"
.text
.globl gated_mix__sliding_block__linear_attn_block__prompt_kernel
.p2align 8
.type gated_mix__sliding_block__linear_attn_block__prompt_kernel,@function
gated_mix__sliding_block__linear_attn_block__prompt_kernel:
s_cmp_ge_u32 s2, 256
s_cbranch_scc1 L_end
s_load_dwordx16 s[4:19], s[0:1], 0
s_load_dwordx4 s[20:23], s[0:1], 64
v_lshrrev_b32 v15, 6, v0
v_and_b32 v1, 63, v0
v_readfirstlane_b32 s56, v15
v_lshlrev_b32 v2, 4, v1
s_and_b32 s53, s2, 3
s_lshl_b32 s53, s53, 2
s_lshr_b32 s59, s2, 6
s_add_u32 s59, s59, s53
s_bfe_u32 s53, s2, 0x10002
s_lshl_b32 s53, s53, 2
s_bfe_u32 s60, s2, 0x20004
s_add_u32 s60, s60, s53
s_bfe_u32 s61, s2, 0x10003
s_and_b32 s57, s56, 3
s_lshr_b32 s58, s56, 2
s_lshl_b32 s67, s56, 10
s_lshl_b32 s65, s59, 4
s_add_u32 s65, s65, s56
s_mul_i32 s65, s65, 7168
s_mul_i32 s100, s56, 21504
s_mul_i32 s53, s60, 112
s_add_u32 s100, s100, s53
s_mul_i32 s53, s59, 1
s_mul_i32 s54, s60, 1
s_add_u32 s53, s53, s54
s_mul_i32 s54, s61, 0
s_add_u32 s53, s53, s54
s_mul_i32 s54, s53, 147
s_lshr_b32 s54, s54, 10
s_mul_i32 s54, s54, 7
s_sub_u32 s63, s53, s54
s_mov_b32 s68, s63
v_lshrrev_b32 v5, 3, v1
v_and_b32 v6, 7, v1
s_and_b32 s53, s56, 1
s_lshl_b32 s53, s53, 2
v_lshrrev_b32 v7, 1, v5
v_add_u32 v7, s53, v7
v_xor_b32 v7, v7, v6
v_mul_u32_u24 v3, 896, v5
v_lshl_add_u32 v3, v7, 4, v3
v_and_b32 v7, 2, v5
v_lshlrev_b32 v7, 1, v7
v_xor_b32 v7, v7, v6
v_mul_u32_u24 v4, 2688, v5
v_lshl_add_u32 v4, v7, 4, v4
v_add_u32 v7, 1, v7
v_lshrrev_b32 v7, 3, v7
v_lshl_add_u32 v4, v7, 30, v4
s_waitcnt lgkmcnt(0)
s_mov_b32 s24, s4
s_mov_b32 s25, s5
s_mov_b32 s26, 1835008
s_mov_b32 s27, 0x20000
s_cmp_eq_u32 s61, 0
s_cselect_b32 s28, s6, s12
s_cselect_b32 s29, s7, s13
s_mov_b32 s30, 1204224
s_mov_b32 s31, 0x20000
s_cmp_eq_u32 s61, 0
s_cbranch_scc0 L_typeB
s_lshl_b32 s101, s63, 7
s_add_u32 s101, s101, s65
s_add_u32 m0, s67, 0
s_nop 0
buffer_load_dwordx4 v3, s[24:27], s101 offen lds
s_add_u32 m0, s67, 8192
s_add_u32 s52, s101, 57344
buffer_load_dwordx4 v3, s[24:27], s52 offen lds
s_mul_i32 s0, s63, 172032
s_add_u32 s0, s0, s100
s_add_u32 m0, s67, 114688
s_add_u32 s52, s0, 896
buffer_load_dwordx4 v4, s[28:31], s52 offen lds
s_mov_b32 s40, s14
s_mov_b32 s41, s15
s_mov_b32 s42, 401408
s_mov_b32 s43, 0x20000
s_mov_b32 s44, s8
s_mov_b32 s45, s9
s_mov_b32 s46, 401408
s_mov_b32 s47, 0x20000
s_lshl_b32 s62, s60, 1
s_add_u32 s62, s62, s58
s_lshl_b32 s64, s59, 2
s_add_u32 s64, s64, s57
v_and_b32 v9, 31, v1
v_lshrrev_b32 v10, 5, v1
v_bfe_u32 v11, v1, 1, 3
s_lshl_b32 s53, s57, 12
v_lshl_add_u32 v9, v9, 7, s53
v_add_u32 v15, 0, v10
v_xor_b32 v15, v15, v11
v_lshl_add_u32 v5, v15, 4, v9
v_add_u32 v15, 2, v10
v_xor_b32 v15, v15, v11
v_lshl_add_u32 v6, v15, 4, v9
v_add_u32 v15, 4, v10
v_xor_b32 v15, v15, v11
v_lshl_add_u32 v7, v15, 4, v9
v_add_u32 v15, 6, v10
v_xor_b32 v15, v15, v11
v_lshl_add_u32 v8, v15, 4, v9
v_bfe_u32 v241, v1, 4, 1
v_and_b32 v242, 3, v1
v_lshlrev_b32 v241, 5, v241
v_lshl_add_u32 v241, v242, 3, v241
s_mul_i32 s53, s58, 56
v_cmp_eq_u32 s[54:55], 56, v241
v_add_u32 v241, s53, v241
v_mov_b32 v242, 112
v_cndmask_b32 v241, v241, v242, s[54:55]
v_bfe_u32 v242, v1, 2, 2
v_and_b32 v243, 2, v242
v_lshlrev_b32 v243, 5, v243
v_xor_b32 v241, v241, v243
v_lshl_add_u32 v242, v10, 3, v242
v_lshl_add_u32 v9, v242, 7, v241
v_add_u32 v10, 0x10000, v9
v_add_u32 v11, 0x20000, v9
s_lshr_b32 s53, s2, 3
s_or_b32 s53, s53, s56
s_cbranch_scc1 Lnn_1
s_memrealtime s[54:55]
s_waitcnt lgkmcnt(0)
s_or_b32 s54, s54, 1
v_mov_b32 v242, s54
v_mov_b32 v243, 0
s_mov_b64 exec, 1
global_atomic_cmpswap v243, v[242:243], s[20:21] sc1
s_mov_b64 exec, -1
Lnn_1:
s_add_u32 s22, s22, 251658240
s_addc_u32 s23, s23, 0
s_mov_b32 s32, s22
s_mov_b32 s33, s23
s_mov_b32 s34, 12582912
s_mov_b32 s35, 0x20000
s_mov_b32 s36, s16
s_mov_b32 s37, s17
s_mov_b32 s38, 896
s_mov_b32 s39, 0x20000
v_lshrrev_b32 v242, 3, v1
v_add_u32 v242, s68, v242
v_subrev_u32 v15, 7, v242
v_min_u32 v242, v242, v15
v_lshlrev_b32 v15, 7, v242
v_and_b32 v241, 7, v1
v_lshl_add_u32 v15, v241, 1, v15
s_lshl_b32 s52, s56, 4
buffer_load_ushort v12, v15, s[36:39], s52 offen
s_mov_b32 s48, s18
s_mov_b32 s49, s19
s_mov_b32 s50, 1835008
s_mov_b32 s51, 0x20000
s_mov_b32 s38, 0xF7F77F7F
s_mov_b32 s39, 0xF7F77F7F
s_lshr_b32 s55, s2, 4
s_cmp_eq_u32 s61, 0
s_cselect_b32 s68, 16, 0
s_add_u32 s55, s55, s68
s_mul_i32 s53, s55, 37
s_lshr_b32 s53, s53, 8
s_mul_i32 s54, s53, 7
s_sub_u32 s68, s55, s54
s_cmp_ge_u32 s55, 28
s_cselect_b32 s69, 1, 0
s_cselect_b32 s68, 0, s68
s_cselect_b32 s53, 0, s53
s_and_b32 s54, s2, 7
s_lshl_b32 s54, s54, 2
s_add_u32 s53, s53, s54
s_lshl_b32 s53, s53, 1
s_add_u32 s53, s53, s58
s_mul_i32 s37, s53, 28672
s_lshl_b32 s68, s68, 7
s_add_u32 s37, s37, s68
s_lshl_b32 s54, s57, 5
s_add_u32 s37, s37, s54
s_lshl_b32 s53, s53, 2
s_add_u32 s53, s53, s57
s_lshl_b32 s53, s53, 2
s_mul_i32 s36, s53, 128
s_add_u32 s36, s36, 9830400
s_lshl_b32 s53, s53, 11
s_bfe_u32 s54, s68, 0x10007
s_lshl_b32 s54, s54, 12
s_add_u32 s53, s53, s54
s_xor_b32 s54, s53, 4096
s_add_u32 s16, s53, 6291456
s_add_u32 s17, s54, 6291456
s_add_u32 s18, s53, 4194304
s_add_u32 s19, s54, 4194304
s_mul_i32 s10, s56, 7168
s_add_u32 s10, s10, s68
s_mov_b32 s15, s69
s_lshl_b32 s54, s64, 4
s_add_u32 s54, s54, s62
s_cmp_eq_u32 s61, 0
s_cselect_b32 s53, 0, 2097152
s_cselect_b32 s55, 0, 131072
s_lshl_b32 s8, s54, 11
s_add_u32 s8, s8, s53
s_add_u32 s8, s8, 4194304
s_mul_i32 s9, s54, 128
s_add_u32 s9, s9, s55
s_add_u32 s9, s9, 9699328
v_lshlrev_b32 v254, 24, v1
v_mov_b32 v13, 0
v_and_b32 v241, 7, v1
v_lshlrev_b32 v14, 7, v241
v_and_b32 v241, 2, v241
v_lshlrev_b32 v241, 5, v241
v_xor_b32 v241, 112, v241
v_add3_u32 v14, v14, v241, s67
v_lshrrev_b32 v241, 3, v1
v_lshl_add_u32 v14, v241, 13, v14
v_lshrrev_b32 v241, 4, v1
v_lshl_add_u32 v14, v241, 13, v14
v_add_u32 v14, 57344, v14
s_add_u32 s63, s63, 1
s_cmp_eq_u32 s63, 7
s_cselect_b32 s63, 0, s63
s_lshl_b32 s101, s63, 7
s_add_u32 s101, s101, s65
s_add_u32 m0, s67, 16384
s_nop 0
buffer_load_dwordx4 v3, s[24:27], s101 offen lds
s_add_u32 m0, s67, 24576
s_add_u32 s52, s101, 57344
buffer_load_dwordx4 v3, s[24:27], s52 offen lds
s_mul_i32 s1, s63, 172032
s_add_u32 s1, s1, s100
s_add_u32 m0, s67, 122880
s_add_u32 s52, s1, 896
buffer_load_dwordx4 v4, s[28:31], s52 offen lds
s_waitcnt vmcnt(4)
s_barrier
ds_read_b128 v[112:115], v5 offset:0
ds_read_b64_tr_b16 v[48:49], v10 offset:49152
ds_read_b64_tr_b16 v[50:51], v10 offset:49664
s_add_u32 s63, s63, 1
s_cmp_eq_u32 s63, 7
s_cselect_b32 s63, 0, s63
s_lshl_b32 s101, s63, 7
s_add_u32 s101, s101, s65
s_add_u32 m0, s67, 32768
s_nop 0
buffer_load_dwordx4 v3, s[24:27], s101 offen lds
s_add_u32 m0, s67, 40960
s_add_u32 s52, s101, 57344
buffer_load_dwordx4 v3, s[24:27], s52 offen lds
s_mul_i32 s66, s63, 172032
s_add_u32 s66, s66, s100
s_add_u32 m0, s67, 131072
s_add_u32 s52, s66, 896
buffer_load_dwordx4 v4, s[28:31], s52 offen lds
s_add_u32 s63, s63, 1
s_cmp_eq_u32 s63, 7
s_cselect_b32 s63, 0, s63
s_lshl_b32 s101, s63, 7
s_add_u32 s101, s101, s65
s_add_u32 m0, s67, 49152
s_nop 0
buffer_load_dwordx4 v3, s[24:27], s101 offen lds
s_add_u32 m0, s67, 57344
s_add_u32 s52, s101, 57344
buffer_load_dwordx4 v3, s[24:27], s52 offen lds
s_mul_i32 s5, s63, 172032
s_add_u32 s5, s5, s100
s_add_u32 m0, s67, 139264
s_add_u32 s52, s5, 896
buffer_load_dwordx4 v4, s[28:31], s52 offen lds
ds_read_b128 v[116:119], v6 offset:0
ds_read_b64_tr_b16 v[52:53], v10 offset:51200
ds_read_b64_tr_b16 v[54:55], v10 offset:51712
ds_read_b128 v[120:123], v7 offset:0
ds_read_b64_tr_b16 v[56:57], v10 offset:53248
ds_read_b64_tr_b16 v[58:59], v10 offset:53760
ds_read_b128 v[124:127], v8 offset:0
ds_read_b64_tr_b16 v[60:61], v10 offset:55296
ds_read_b64_tr_b16 v[62:63], v10 offset:55808
s_waitcnt vmcnt(6)
s_barrier
ds_read_b128 v[128:131], v5 offset:16384
ds_read_b64_tr_b16 v[64:65], v10 offset:57344
ds_read_b64_tr_b16 v[66:67], v10 offset:57856
s_waitcnt lgkmcnt(9)
v_mfma_f32_32x32x16_bf16 v[16:31], v[48:51], v[112:115], 0
s_add_u32 s63, s63, 1
s_cmp_eq_u32 s63, 7
s_cselect_b32 s63, 0, s63
s_lshl_b32 s101, s63, 7
s_add_u32 s101, s101, s65
s_add_u32 m0, s67, 65536
s_nop 0
buffer_load_dwordx4 v3, s[24:27], s101 offen lds
s_add_u32 m0, s67, 73728
s_add_u32 s52, s101, 57344
buffer_load_dwordx4 v3, s[24:27], s52 offen lds
s_mul_i32 s7, s63, 172032
s_add_u32 s7, s7, s100
s_add_u32 m0, s67, 147456
s_add_u32 s52, s7, 896
buffer_load_dwordx4 v4, s[28:31], s52 offen lds
ds_read_b128 v[132:135], v6 offset:16384
ds_read_b64_tr_b16 v[68:69], v10 offset:59392
ds_read_b64_tr_b16 v[70:71], v10 offset:59904
v_mfma_f32_32x32x16_bf16 v[16:31], v[52:55], v[116:119], v[16:31]
v_mov_b32 v247, 0
global_load_dword v246, v247, s[20:21] sc1
ds_read_b128 v[136:139], v7 offset:16384
ds_read_b64_tr_b16 v[72:73], v10 offset:61440
ds_read_b64_tr_b16 v[74:75], v10 offset:61952
s_waitcnt lgkmcnt(9)
v_mfma_f32_32x32x16_bf16 v[16:31], v[56:59], v[120:123], v[16:31]
s_lshl_b32 s53, s62, 6
s_add_u32 s53, s53, s64
s_lshl_b32 s4, s53, 11
s_mul_i32 s6, s53, 128
s_add_u32 s6, s6, 9437184
s_mul_i32 s53, s58, 24576
s_lshl_b32 s54, s57, 11
s_add_u32 s53, s53, s54
v_add_u32 v102, s53, v2
v_add_u32 v103, 8192, v102
v_add_u32 v104, 57344, v102
v_add_u32 v102, 24576, v102
ds_read_b128 v[140:143], v8 offset:16384
ds_read_b64_tr_b16 v[76:77], v10 offset:63488
ds_read_b64_tr_b16 v[78:79], v10 offset:64000
v_mfma_f32_32x32x16_bf16 v[16:31], v[60:63], v[124:127], v[16:31]
s_add_u32 s14, s53, s54
v_mov_b32 v106, 0x3e8b97f6
v_mov_b32 v107, 0x3e8b97f6
v_mov_b32 v108, 0
v_mov_b32 v109, 0
s_mov_b32 exec_hi, 0
v_mov_b32 v108, 0x3e8b97f6
v_mov_b32 v109, 0x3e8b97f6
s_mov_b32 exec_hi, -1
v_mov_b32 v110, 0x3f803f80
v_mov_b32 v111, 0x3f803f80
v_and_b32 v248, 1, v1
v_mul_u32_u24 v248, 128, v248
s_waitcnt vmcnt(7)
s_barrier
ds_read_b128 v[144:147], v5 offset:32768
ds_read_b64_tr_b16 v[48:49], v11 offset:0
ds_read_b64_tr_b16 v[50:51], v11 offset:512
s_waitcnt lgkmcnt(9)
v_mfma_f32_32x32x16_bf16 v[16:31], v[64:67], v[128:131], v[16:31]
s_add_u32 s63, s63, 1
s_cmp_eq_u32 s63, 7
s_cselect_b32 s63, 0, s63
s_lshl_b32 s101, s63, 7
s_add_u32 s101, s101, s65
s_add_u32 m0, s67, 81920
s_nop 0
buffer_load_dwordx4 v3, s[24:27], s101 offen lds
s_add_u32 m0, s67, 90112
s_add_u32 s52, s101, 57344
buffer_load_dwordx4 v3, s[24:27], s52 offen lds
s_mul_i32 s11, s63, 172032
s_add_u32 s11, s11, s100
s_add_u32 m0, s67, 155648
s_add_u32 s52, s11, 896
buffer_load_dwordx4 v4, s[28:31], s52 offen lds
ds_read_b128 v[148:151], v6 offset:32768
ds_read_b64_tr_b16 v[52:53], v11 offset:2048
ds_read_b64_tr_b16 v[54:55], v11 offset:2560
v_mfma_f32_32x32x16_bf16 v[16:31], v[68:71], v[132:135], v[16:31]
v_and_b32 v253, 3, v1
v_mul_u32_u24 v253, 128, v253
ds_read_b128 v[152:155], v7 offset:32768
ds_read_b64_tr_b16 v[56:57], v11 offset:4096
ds_read_b64_tr_b16 v[58:59], v11 offset:4608
s_waitcnt lgkmcnt(9)
v_mfma_f32_32x32x16_bf16 v[16:31], v[72:75], v[136:139], v[16:31]
s_lshr_b32 s53, s2, 4
s_lshl_b32 s53, s53, 3
s_and_b32 s54, s2, 7
s_add_u32 s53, s53, s54
s_mul_i32 s53, s53, 49
v_min_u32 v241, 48, v1
v_add_u32 v241, s53, v241
s_mov_b32 s53, 306783379
v_mul_hi_u32 v242, s53, v241
v_mul_u32_u24 v243, 14, v242
v_sub_u32 v241, v241, v243
s_cmp_ge_u32 s56, 1
s_cselect_b32 s54, 1879048192, 0
s_cmp_eq_u32 s56, 0
s_cbranch_scc0 Lpf1_2
v_add_u32 v243, 1, v241
v_lshrrev_b32 v243, 3, v243
v_mul_u32_u24 v243, 7, v243
v_add_u32 v241, v241, v243
v_mul_u32_u24 v242, 2688, v242
v_lshl_add_u32 v241, v241, 7, v242
buffer_load_dword v0, v241, s[28:31], 0 offen
s_branch Lpfd_4
Lpf1_2:
v_mad_u32_u24 v241, v242, 14, v241
v_lshlrev_b32 v241, 6, v241
s_cmp_eq_u32 s56, 1
s_cbranch_scc0 Lpf2_3
buffer_load_dword v0, v241, s[40:43], s54 offen
s_branch Lpfd_4
Lpf2_3:
buffer_load_dword v0, v241, s[44:47], s54 offen
Lpfd_4:
ds_read_b128 v[156:159], v8 offset:32768
ds_read_b64_tr_b16 v[60:61], v11 offset:6144
ds_read_b64_tr_b16 v[62:63], v11 offset:6656
v_mfma_f32_32x32x16_bf16 v[16:31], v[76:79], v[140:143], v[16:31]
v_lshrrev_b32 v241, 5, v1
v_bfe_u32 v242, v1, 2, 2
v_lshl_add_u32 v243, v241, 2, v242
s_bfe_u32 s54, s37, 0x10007
s_mul_i32 s54, s54, 7168
s_mul_i32 s53, s57, 14336
s_add_u32 s53, s53, s54
s_add_u32 s53, s53, 106496
s_lshl_b32 s59, s54, 1
s_sub_u32 s59, s59, 7168
v_lshl_add_u32 v243, v243, 7, s53
v_and_b32 v242, 2, v242
v_lshlrev_b32 v242, 5, v242
s_waitcnt vmcnt(8)
s_barrier
ds_read_b128 v[160:163], v5 offset:49152
ds_read_b64_tr_b16 v[64:65], v11 offset:8192
ds_read_b64_tr_b16 v[66:67], v11 offset:8704
s_waitcnt lgkmcnt(9)
v_mfma_f32_32x32x16_bf16 v[16:31], v[48:51], v[144:147], v[16:31]
s_add_u32 s63, s63, 1
s_cmp_eq_u32 s63, 7
s_cselect_b32 s63, 0, s63
s_lshl_b32 s101, s63, 7
s_add_u32 s101, s101, s65
s_add_u32 m0, s67, 98304
s_nop 0
buffer_load_dwordx4 v3, s[24:27], s101 offen lds
s_add_u32 m0, s67, 106496
s_add_u32 s52, s101, 57344
buffer_load_dwordx4 v3, s[24:27], s52 offen lds
s_mul_i32 s13, s63, 172032
s_add_u32 s13, s13, s100
s_add_u32 m0, s67, 114688
s_add_u32 s52, s13, 896
buffer_load_dwordx4 v4, s[28:31], s52 offen lds
ds_read_b128 v[164:167], v6 offset:49152
ds_read_b64_tr_b16 v[68:69], v11 offset:10240
ds_read_b64_tr_b16 v[70:71], v11 offset:10752
v_mfma_f32_32x32x16_bf16 v[16:31], v[52:55], v[148:151], v[16:31]
v_and_b32 v244, 3, v1
v_lshlrev_b32 v244, 3, v244
v_and_b32 v92, 31, v1
v_mul_u32_u24 v92, 896, v92
v_lshl_add_u32 v92, v241, 4, v92
s_mov_b32 s60, 0
s_mov_b32 s61, -1
v_bfe_u32 v84, v1, 2, 2
v_mad_u32_u24 v85, v84, 6, 4
v_add_u32 v84, 13, v84
v_bfe_u32 v86, v1, 2, 1
v_add_u32 v86, -1, v86
v_and_b32 v85, v85, v86
ds_read_b128 v[168:171], v7 offset:49152
ds_read_b64_tr_b16 v[72:73], v11 offset:12288
ds_read_b64_tr_b16 v[74:75], v11 offset:12800
s_waitcnt lgkmcnt(9)
v_mfma_f32_32x32x16_bf16 v[16:31], v[56:59], v[152:155], v[16:31]
v_cndmask_b32 v84, v84, v85, s[60:61]
v_cndmask_b32 v241, v242, 64, s[60:61]
v_lshl_add_u32 v84, v84, 7, s53
v_bfe_u32 v15, v1, 4, 1
v_add_u32 v15, 0, v15
v_xor_b32 v15, s57, v15
v_lshl_add_u32 v15, v15, 5, v244
v_xor_b32 v85, v15, v242
v_xor_b32 v15, v15, v241
v_add_u32 v80, v243, v85
v_add_u32 v82, v84, v15
v_bfe_u32 v15, v1, 4, 1
v_add_u32 v15, 2, v15
v_xor_b32 v15, s57, v15
ds_read_b128 v[172:175], v8 offset:49152
ds_read_b64_tr_b16 v[76:77], v11 offset:14336
ds_read_b64_tr_b16 v[78:79], v11 offset:14848
v_mfma_f32_32x32x16_bf16 v[16:31], v[60:63], v[156:159], v[16:31]
v_lshl_add_u32 v15, v15, 5, v244
v_xor_b32 v85, v15, v242
v_xor_b32 v15, v15, v241
v_add_u32 v81, v243, v85
v_add_u32 v83, v84, v15
v_subrev_u32 v84, 106496, v80
v_subrev_u32 v85, 106496, v81
v_subrev_u32 v86, 106496, v82
v_subrev_u32 v87, 106496, v83
s_mul_i32 s53, s58, 24576
s_add_u32 s53, s53, 57344
s_xor_b32 s54, s57, 0
s_mul_i32 s54, s54, 6144
s_add_u32 s54, s54, s53
s_waitcnt vmcnt(8)
s_barrier
v_add_u32 v5, 0x10000, v5
v_add_u32 v6, 0x10000, v6
v_add_u32 v7, 0x10000, v7
v_add_u32 v8, 0x10000, v8
ds_read_b128 v[176:179], v5 offset:0
ds_read_b64_tr_b16 v[48:49], v11 offset:16384
ds_read_b64_tr_b16 v[50:51], v11 offset:16896
s_waitcnt lgkmcnt(9)
v_mfma_f32_32x32x16_bf16 v[16:31], v[64:67], v[160:163], v[16:31]
s_add_u32 m0, s67, 8192
s_add_u32 s52, s0, 1792
buffer_load_dwordx4 v4, s[28:31], s52 offen lds
ds_read_b128 v[180:183], v6 offset:0
ds_read_b64_tr_b16 v[52:53], v11 offset:18432
ds_read_b64_tr_b16 v[54:55], v11 offset:18944
v_mfma_f32_32x32x16_bf16 v[16:31], v[68:71], v[164:167], v[16:31]
v_add_u32 v88, s54, v2
s_xor_b32 s54, s57, 1
s_mul_i32 s54, s54, 6144
s_add_u32 s54, s54, s53
v_add_u32 v89, s54, v2
s_xor_b32 s54, s57, 2
s_mul_i32 s54, s54, 6144
s_add_u32 s54, s54, s53
v_add_u32 v90, s54, v2
s_xor_b32 s54, s57, 3
s_mul_i32 s54, s54, 6144
s_add_u32 s54, s54, s53
ds_read_b128 v[184:187], v7 offset:0
ds_read_b64_tr_b16 v[56:57], v11 offset:20480
ds_read_b64_tr_b16 v[58:59], v11 offset:20992
s_waitcnt lgkmcnt(9)
v_mfma_f32_32x32x16_bf16 v[16:31], v[72:75], v[168:171], v[16:31]
v_add_u32 v91, s54, v2
ds_read_b128 v[188:191], v8 offset:0
ds_read_b64_tr_b16 v[60:61], v11 offset:22528
ds_read_b64_tr_b16 v[62:63], v11 offset:23040
v_mfma_f32_32x32x16_bf16 v[16:31], v[76:79], v[172:175], v[16:31]
s_waitcnt vmcnt(5)
s_barrier
ds_read_b128 v[192:195], v5 offset:16384
ds_read_b64_tr_b16 v[64:65], v11 offset:24576
ds_read_b64_tr_b16 v[66:67], v11 offset:25088
s_waitcnt lgkmcnt(9)
v_mfma_f32_32x32x16_bf16 v[16:31], v[48:51], v[176:179], v[16:31]
s_add_u32 m0, s67, 16384
s_add_u32 s52, s1, 1792
buffer_load_dwordx4 v4, s[28:31], s52 offen lds
s_add_u32 m0, s67, 32768
s_add_u32 s52, s66, 1792
buffer_load_dwordx4 v4, s[28:31], s52 offen lds
ds_read_b128 v[196:199], v6 offset:16384
ds_read_b64_tr_b16 v[68:69], v11 offset:26624
ds_read_b64_tr_b16 v[70:71], v11 offset:27136
v_mfma_f32_32x32x16_bf16 v[16:31], v[52:55], v[180:183], v[16:31]
s_mov_b32 s26, s10
s_mov_b32 s27, s15
v_lshrrev_b32 v244, 3, v1
v_mul_u32_u24 v3, 896, v244
v_and_b32 v244, 2, v244
v_lshlrev_b32 v244, 1, v244
v_and_b32 v241, 7, v1
v_xor_b32 v244, v244, v241
v_lshl_add_u32 v3, v244, 4, v3
ds_read_b128 v[200:203], v7 offset:16384
ds_read_b64_tr_b16 v[72:73], v11 offset:28672
ds_read_b64_tr_b16 v[74:75], v11 offset:29184
s_waitcnt lgkmcnt(9)
v_mfma_f32_32x32x16_bf16 v[16:31], v[56:59], v[184:187], v[16:31]
s_add_u32 s53, s64, s57
s_sub_u32 s53, s53, 8
s_max_i32 s54, s53, 0
s_lshl_b32 s55, s62, 6
s_add_u32 s54, s54, s55
s_mul_i32 s12, s54, 128
s_add_u32 s12, s12, 9437184
s_lshl_b32 s54, s54, 11
s_cmp_ge_i32 s53, 0
s_cselect_b32 s10, s54, 1879048192
s_cselect_b32 s15, 1, 0
ds_read_b128 v[204:207], v8 offset:16384
ds_read_b64_tr_b16 v[76:77], v11 offset:30720
ds_read_b64_tr_b16 v[78:79], v11 offset:31232
v_mfma_f32_32x32x16_bf16 v[16:31], v[60:63], v[188:191], v[16:31]
s_waitcnt vmcnt(3)
s_barrier
ds_read_b128 v[208:211], v5 offset:32768
ds_read_b64_tr_b16 v[48:49], v10 offset:49152
ds_read_b64_tr_b16 v[50:51], v10 offset:49664
s_waitcnt lgkmcnt(9)
v_mfma_f32_32x32x16_bf16 v[16:31], v[64:67], v[192:195], v[16:31]
s_add_u32 m0, s67, 40960
s_add_u32 s52, s5, 1792
buffer_load_dwordx4 v4, s[28:31], s52 offen lds
ds_read_b128 v[212:215], v6 offset:32768
ds_read_b64_tr_b16 v[52:53], v10 offset:51200
ds_read_b64_tr_b16 v[54:55], v10 offset:51712
v_mfma_f32_32x32x16_bf16 v[16:31], v[68:71], v[196:199], v[16:31]
ds_read_b128 v[216:219], v7 offset:32768
ds_read_b64_tr_b16 v[56:57], v10 offset:53248
ds_read_b64_tr_b16 v[58:59], v10 offset:53760
s_waitcnt lgkmcnt(9)
v_mfma_f32_32x32x16_bf16 v[16:31], v[72:75], v[200:203], v[16:31]
ds_read_b128 v[220:223], v8 offset:32768
ds_read_b64_tr_b16 v[60:61], v10 offset:55296
ds_read_b64_tr_b16 v[62:63], v10 offset:55808
v_mfma_f32_32x32x16_bf16 v[16:31], v[76:79], v[204:207], v[16:31]
v_cmp_eq_u32 vcc, 0, v246
s_cbranch_vccnz Lnon_5
Lnonb_6:
v_readfirstlane_b32 s63, v246
v_and_b32 v5, 3, v1
v_lshlrev_b32 v5, 3, v5
v_lshrrev_b32 v5, v5, v246
v_and_b32 v5, 0x9f7f, v5
v_or_b32 v5, 0x80, v5
v_lshlrev_b32 v5, 16, v5
s_add_u32 s53, s36, -131072
s_add_u32 s20, s22, s53
s_addc_u32 s21, s23, 0
s_add_u32 s24, s22, s36
s_addc_u32 s25, s23, 0
s_waitcnt vmcnt(2)
s_barrier
ds_read_b64_tr_b16 v[64:65], v9 offset:8192
ds_read_b64_tr_b16 v[66:67], v9 offset:8704
s_waitcnt lgkmcnt(8)
v_mfma_f32_32x32x16_bf16 v[16:31], v[48:51], v[208:211], v[16:31]
s_add_u32 m0, s67, 139264
s_add_u32 s52, s7, 1792
buffer_load_dwordx4 v4, s[28:31], s52 offen lds
ds_read_b64_tr_b16 v[68:69], v9 offset:10240
ds_read_b64_tr_b16 v[70:71], v9 offset:10752
v_mfma_f32_32x32x16_bf16 v[16:31], v[52:55], v[212:215], v[16:31]
ds_read_b64_tr_b16 v[72:73], v9 offset:12288
ds_read_b64_tr_b16 v[74:75], v9 offset:12800
s_waitcnt lgkmcnt(6)
v_mfma_f32_32x32x16_bf16 v[16:31], v[56:59], v[216:219], v[16:31]
ds_read_b64_tr_b16 v[76:77], v9 offset:14336
ds_read_b64_tr_b16 v[78:79], v9 offset:14848
v_mfma_f32_32x32x16_bf16 v[16:31], v[60:63], v[220:223], v[16:31]
ds_read_b64_tr_b16 v[48:49], v9 offset:16384
ds_read_b64_tr_b16 v[50:51], v9 offset:16896
s_waitcnt lgkmcnt(6)
v_mfma_f32_32x32x16_bf16 v[32:47], v[112:115], v[64:67], 0
s_add_u32 m0, s67, 147456
s_add_u32 s52, s11, 1792
buffer_load_dwordx4 v4, s[28:31], s52 offen lds
ds_read_b64_tr_b16 v[52:53], v9 offset:18432
ds_read_b64_tr_b16 v[54:55], v9 offset:18944
v_mfma_f32_32x32x16_bf16 v[32:47], v[116:119], v[68:71], v[32:47]
s_nop 1
v_pk_mul_f32 v[16:17], v[16:17], v[106:107]
v_pk_mul_f32 v[18:19], v[18:19], v[106:107]
v_pk_mul_f32 v[20:21], v[20:21], v[106:107]
v_pk_mul_f32 v[22:23], v[22:23], v[106:107]
v_pk_mul_f32 v[24:25], v[24:25], v[106:107]
v_pk_mul_f32 v[26:27], v[26:27], v[106:107]
v_pk_mul_f32 v[28:29], v[28:29], v[108:109]
v_pk_mul_f32 v[30:31], v[30:31], v[108:109]
ds_read_b64_tr_b16 v[56:57], v9 offset:20480
ds_read_b64_tr_b16 v[58:59], v9 offset:20992
s_waitcnt lgkmcnt(6)
v_mfma_f32_32x32x16_bf16 v[32:47], v[120:123], v[72:75], v[32:47]
v_cvt_pk_bf16_f32 v224, v16, v17
v_cvt_pk_bf16_f32 v225, v18, v19
v_cvt_pk_bf16_f32 v226, v20, v21
v_cvt_pk_bf16_f32 v227, v22, v23
v_cvt_pk_bf16_f32 v228, v24, v25
v_cvt_pk_bf16_f32 v229, v26, v27
v_cvt_pk_bf16_f32 v230, v28, v29
v_cvt_pk_bf16_f32 v231, v30, v31
ds_read_b64_tr_b16 v[60:61], v9 offset:22528
ds_read_b64_tr_b16 v[62:63], v9 offset:23040
v_mfma_f32_32x32x16_bf16 v[32:47], v[124:127], v[76:79], v[32:47]
buffer_store_dwordx4 v[224:227], v2, s[32:35], s4 offen offset:0 sc1
ds_write_b128 v102, v[224:227] offset:0
buffer_store_dwordx4 v[228:231], v2, s[32:35], s4 offen offset:1024 sc1
s_waitcnt vmcnt(4)
s_waitcnt lgkmcnt(0)
s_barrier
ds_read_b64_tr_b16 v[64:65], v9 offset:32768
ds_read_b64_tr_b16 v[66:67], v9 offset:33280
v_mfma_f32_32x32x16_bf16 v[32:47], v[128:131], v[48:51], v[32:47]
s_add_u32 m0, s67, 155648
s_add_u32 s52, s13, 1792
buffer_load_dwordx4 v4, s[28:31], s52 offen lds
ds_read_b64_tr_b16 v[68:69], v9 offset:34816
ds_read_b64_tr_b16 v[70:71], v9 offset:35328
v_mfma_f32_32x32x16_bf16 v[32:47], v[132:135], v[52:55], v[32:47]
ds_write_b128 v102, v[228:231] offset:1024
ds_read_b64_tr_b16 v[72:73], v9 offset:36864
ds_read_b64_tr_b16 v[74:75], v9 offset:37376
v_mfma_f32_32x32x16_bf16 v[32:47], v[136:139], v[56:59], v[32:47]
s_mov_b32 exec_hi, 0xffffff
ds_write_b64 v14, v[12:13]
s_mov_b32 exec_hi, -1
ds_read_b64_tr_b16 v[76:77], v9 offset:38912
ds_read_b64_tr_b16 v[78:79], v9 offset:39424
v_mfma_f32_32x32x16_bf16 v[32:47], v[140:143], v[60:63], v[32:47]
ds_read_b64_tr_b16 v[48:49], v9 offset:40960
ds_read_b64_tr_b16 v[50:51], v9 offset:41472
s_waitcnt lgkmcnt(8)
v_mfma_f32_32x32x16_bf16 v[32:47], v[144:147], v[64:67], v[32:47]
s_mov_b64 exec, s[38:39]
s_add_u32 m0, s67, 57344
s_nop 0
buffer_load_dwordx4 v4, s[28:31], s0 offen lds
s_mov_b64 exec, -1
ds_read_b64_tr_b16 v[52:53], v9 offset:43008
ds_read_b64_tr_b16 v[54:55], v9 offset:43520
v_mfma_f32_32x32x16_bf16 v[32:47], v[148:151], v[68:71], v[32:47]
ds_read_b64_tr_b16 v[56:57], v9 offset:45056
ds_read_b64_tr_b16 v[58:59], v9 offset:45568
s_waitcnt lgkmcnt(6)
v_mfma_f32_32x32x16_bf16 v[32:47], v[152:155], v[72:75], v[32:47]
ds_read_b64_tr_b16 v[60:61], v9 offset:47104
ds_read_b64_tr_b16 v[62:63], v9 offset:47616
v_mfma_f32_32x32x16_bf16 v[32:47], v[156:159], v[76:79], v[32:47]
s_waitcnt vmcnt(4)
s_barrier
ds_read_b64_tr_b16 v[64:65], v11 offset:8192
ds_read_b64_tr_b16 v[66:67], v11 offset:8704
s_waitcnt lgkmcnt(6)
v_mfma_f32_32x32x16_bf16 v[32:47], v[160:163], v[48:51], v[32:47]
s_mov_b64 exec, s[38:39]
s_add_u32 m0, s67, 65536
s_nop 0
buffer_load_dwordx4 v4, s[28:31], s1 offen lds
s_mov_b64 exec, -1
ds_read_b64_tr_b16 v[68:69], v11 offset:10240
ds_read_b64_tr_b16 v[70:71], v11 offset:10752
v_mfma_f32_32x32x16_bf16 v[32:47], v[164:167], v[52:55], v[32:47]
ds_read_b64_tr_b16 v[72:73], v11 offset:12288
ds_read_b64_tr_b16 v[74:75], v11 offset:12800
s_waitcnt lgkmcnt(6)
v_mfma_f32_32x32x16_bf16 v[32:47], v[168:171], v[56:59], v[32:47]
ds_read_b64_tr_b16 v[76:77], v11 offset:14336
ds_read_b64_tr_b16 v[78:79], v11 offset:14848
v_mfma_f32_32x32x16_bf16 v[32:47], v[172:175], v[60:63], v[32:47]
s_waitcnt vmcnt(3)
buffer_store_dword v246, v254, s[32:35], s6 offen sc1
ds_read_b64_tr_b16 v[48:49], v11 offset:16384
ds_read_b64_tr_b16 v[50:51], v11 offset:16896
s_waitcnt lgkmcnt(6)
v_mfma_f32_32x32x16_bf16 v[32:47], v[176:179], v[64:67], v[32:47]
s_mov_b64 exec, s[38:39]
s_add_u32 m0, s67, 81920
s_nop 0
buffer_load_dwordx4 v4, s[28:31], s66 offen lds
s_mov_b64 exec, -1
ds_read_b64_tr_b16 v[52:53], v11 offset:18432
ds_read_b64_tr_b16 v[54:55], v11 offset:18944
v_mfma_f32_32x32x16_bf16 v[32:47], v[180:183], v[68:71], v[32:47]
s_bfm_b32 s70, 0, 0
s_bfm_b32 s71, 4, 0
s_bfm_b32 s72, 1, 0
s_bfm_b32 s73, 5, 0
s_bfm_b32 s74, 2, 0
s_bfm_b32 s75, 6, 0
s_bfm_b32 s76, 3, 0
s_bfm_b32 s77, 7, 0
ds_read_b64_tr_b16 v[56:57], v11 offset:20480
ds_read_b64_tr_b16 v[58:59], v11 offset:20992
s_waitcnt lgkmcnt(6)
v_mfma_f32_32x32x16_bf16 v[32:47], v[184:187], v[72:75], v[32:47]
s_bfm_b32 s78, 8, 0
s_bfm_b32 s79, 12, 0
s_bfm_b32 s80, 9, 0
s_bfm_b32 s81, 13, 0
s_bfm_b32 s82, 10, 0
s_bfm_b32 s83, 14, 0
s_bfm_b32 s84, 11, 0
s_bfm_b32 s85, 15, 0
ds_read_b64_tr_b16 v[60:61], v11 offset:22528
ds_read_b64_tr_b16 v[62:63], v11 offset:23040
v_mfma_f32_32x32x16_bf16 v[32:47], v[188:191], v[76:79], v[32:47]
s_bfm_b32 s86, 16, 0
s_bfm_b32 s87, 20, 0
s_bfm_b32 s88, 17, 0
s_bfm_b32 s89, 21, 0
s_bfm_b32 s90, 18, 0
s_bfm_b32 s91, 22, 0
s_bfm_b32 s92, 19, 0
s_bfm_b32 s93, 23, 0
s_waitcnt vmcnt(4)
s_barrier
ds_read_b64_tr_b16 v[64:65], v11 offset:24576
ds_read_b64_tr_b16 v[66:67], v11 offset:25088
s_waitcnt lgkmcnt(6)
v_mfma_f32_32x32x16_bf16 v[32:47], v[192:195], v[48:51], v[32:47]
s_mov_b64 exec, s[38:39]
s_add_u32 m0, s67, 90112
s_nop 0
buffer_load_dwordx4 v4, s[28:31], s5 offen lds
s_mov_b64 exec, -1
ds_read_b64_tr_b16 v[68:69], v11 offset:26624
ds_read_b64_tr_b16 v[70:71], v11 offset:27136
v_mfma_f32_32x32x16_bf16 v[32:47], v[196:199], v[52:55], v[32:47]
s_bfm_b32 s94, 24, 0
s_bfm_b32 s95, 28, 0
s_bfm_b32 s96, 25, 0
s_bfm_b32 s97, 29, 0
s_bfm_b32 s98, 26, 0
s_bfm_b32 s99, 30, 0
s_bfm_b32 s100, 27, 0
s_bfm_b32 s101, 31, 0
ds_read_b64_tr_b16 v[72:73], v11 offset:28672
ds_read_b64_tr_b16 v[74:75], v11 offset:29184
s_waitcnt lgkmcnt(6)
v_mfma_f32_32x32x16_bf16 v[32:47], v[200:203], v[56:59], v[32:47]
v_mov_b32 v241, 0xffff
v_mov_b32 v242, 0xffff0000
v_cndmask_b32 v243, 0, v241, s[70:71]
v_cndmask_b32 v244, 0, v242, s[72:73]
v_or_b32 v94, v243, v244
v_cndmask_b32 v243, 0, v241, s[74:75]
v_cndmask_b32 v244, 0, v242, s[76:77]
v_or_b32 v95, v243, v244
ds_read_b64_tr_b16 v[76:77], v11 offset:30720
ds_read_b64_tr_b16 v[78:79], v11 offset:31232
v_mfma_f32_32x32x16_bf16 v[32:47], v[204:207], v[60:63], v[32:47]
v_cndmask_b32 v243, 0, v241, s[78:79]
v_cndmask_b32 v244, 0, v242, s[80:81]
v_or_b32 v96, v243, v244
v_cndmask_b32 v243, 0, v241, s[82:83]
v_cndmask_b32 v244, 0, v242, s[84:85]
v_or_b32 v97, v243, v244
v_cndmask_b32 v243, 0, v241, s[86:87]
v_cndmask_b32 v244, 0, v242, s[88:89]
s_waitcnt vmcnt(3)
s_barrier
ds_read_b64_tr_b16 v[48:49], v9 offset:57344
ds_read_b64_tr_b16 v[50:51], v9 offset:57856
s_waitcnt lgkmcnt(6)
v_mfma_f32_32x32x16_bf16 v[32:47], v[208:211], v[64:67], v[32:47]
s_mov_b64 exec, s[38:39]
s_add_u32 m0, s67, 106496
s_nop 0
buffer_load_dwordx4 v4, s[28:31], s7 offen lds
s_mov_b64 exec, -1
ds_read_b64_tr_b16 v[52:53], v9 offset:59392
ds_read_b64_tr_b16 v[54:55], v9 offset:59904
v_mfma_f32_32x32x16_bf16 v[32:47], v[212:215], v[68:71], v[32:47]
v_or_b32 v98, v243, v244
v_cndmask_b32 v243, 0, v241, s[90:91]
v_cndmask_b32 v244, 0, v242, s[92:93]
v_or_b32 v99, v243, v244
v_cndmask_b32 v243, 0, v241, s[94:95]
v_cndmask_b32 v244, 0, v242, s[96:97]
v_or_b32 v100, v243, v244
v_cndmask_b32 v243, 0, v241, s[98:99]
ds_read_b64_tr_b16 v[56:57], v9 offset:61440
ds_read_b64_tr_b16 v[58:59], v9 offset:61952
s_waitcnt lgkmcnt(6)
v_mfma_f32_32x32x16_bf16 v[32:47], v[216:219], v[72:75], v[32:47]
v_cndmask_b32 v244, 0, v242, s[100:101]
v_or_b32 v101, v243, v244
ds_read_b64_tr_b16 v[60:61], v9 offset:63488
ds_read_b64_tr_b16 v[62:63], v9 offset:64000
v_mfma_f32_32x32x16_bf16 v[32:47], v[220:223], v[76:79], v[32:47]
ds_read_b64_tr_b16 v[64:65], v10 offset:0
ds_read_b64_tr_b16 v[66:67], v10 offset:512
s_waitcnt lgkmcnt(6)
v_mfma_f32_32x32x16_bf16 v[16:31], v[48:51], v[112:115], 0
s_mov_b64 exec, s[38:39]
s_add_u32 m0, s67, 114688
s_nop 0
buffer_load_dwordx4 v4, s[28:31], s11 offen lds
s_mov_b64 exec, -1
ds_read_b64_tr_b16 v[68:69], v10 offset:2048
ds_read_b64_tr_b16 v[70:71], v10 offset:2560
v_mfma_f32_32x32x16_bf16 v[16:31], v[52:55], v[116:119], v[16:31]
v_cvt_pk_bf16_f32 v224, v32, v33
v_cvt_pk_bf16_f32 v225, v34, v35
v_cvt_pk_bf16_f32 v226, v36, v37
v_cvt_pk_bf16_f32 v227, v38, v39
v_cvt_pk_bf16_f32 v228, v40, v41
v_cvt_pk_bf16_f32 v229, v42, v43
v_cvt_pk_bf16_f32 v230, v44, v45
v_cvt_pk_bf16_f32 v231, v46, v47
ds_read_b64_tr_b16 v[72:73], v10 offset:4096
ds_read_b64_tr_b16 v[74:75], v10 offset:4608
s_waitcnt lgkmcnt(6)
v_mfma_f32_32x32x16_bf16 v[16:31], v[56:59], v[120:123], v[16:31]
s_mov_b32 exec_lo, 0x10000000
s_mov_b32 exec_hi, 0x10000000
v_pk_mov_b32 v[224:225], v[110:111], v[110:111] op_sel:[0,1]
v_pk_mov_b32 v[226:227], v[110:111], v[110:111] op_sel:[0,1]
v_pk_mov_b32 v[228:229], v[110:111], v[110:111] op_sel:[0,1]
v_pk_mov_b32 v[230:231], v[110:111], v[110:111] op_sel:[0,1]
s_mov_b64 exec, -1
s_add_u32 s4, s4, 2097152
s_add_u32 s6, s6, 131072
ds_read_b64_tr_b16 v[76:77], v10 offset:6144
ds_read_b64_tr_b16 v[78:79], v10 offset:6656
v_mfma_f32_32x32x16_bf16 v[16:31], v[60:63], v[124:127], v[16:31]
buffer_store_dwordx4 v[224:227], v2, s[32:35], s4 offen offset:0 sc1
ds_write_b128 v102, v[224:227] offset:49152
buffer_store_dwordx4 v[228:231], v2, s[32:35], s4 offen offset:1024 sc1
s_waitcnt vmcnt(4)
s_waitcnt lgkmcnt(0)
s_barrier
ds_read_b64_tr_b16 v[48:49], v10 offset:16384
ds_read_b64_tr_b16 v[50:51], v10 offset:16896
v_mfma_f32_32x32x16_bf16 v[16:31], v[64:67], v[128:131], v[16:31]
s_mov_b64 exec, s[38:39]
s_add_u32 m0, s67, 131072
s_nop 0
buffer_load_dwordx4 v4, s[28:31], s13 offen lds
s_mov_b64 exec, -1
ds_read_b64_tr_b16 v[52:53], v10 offset:18432
ds_read_b64_tr_b16 v[54:55], v10 offset:18944
v_mfma_f32_32x32x16_bf16 v[16:31], v[68:71], v[132:135], v[16:31]
ds_write_b128 v102, v[228:231] offset:50176
ds_read_b64_tr_b16 v[56:57], v10 offset:20480
ds_read_b64_tr_b16 v[58:59], v10 offset:20992
v_mfma_f32_32x32x16_bf16 v[16:31], v[72:75], v[136:139], v[16:31]
ds_read_b64_tr_b16 v[60:61], v10 offset:22528
ds_read_b64_tr_b16 v[62:63], v10 offset:23040
v_mfma_f32_32x32x16_bf16 v[16:31], v[76:79], v[140:143], v[16:31]
buffer_load_dword v249, v248, s[32:35], s12 offen sc1
ds_read_b64_tr_b16 v[64:65], v10 offset:24576
ds_read_b64_tr_b16 v[66:67], v10 offset:25088
s_waitcnt lgkmcnt(7)
v_mfma_f32_32x32x16_bf16 v[16:31], v[48:51], v[144:147], v[16:31]
ds_read_b64_tr_b16 v[68:69], v10 offset:26624
ds_read_b64_tr_b16 v[70:71], v10 offset:27136
v_mfma_f32_32x32x16_bf16 v[16:31], v[52:55], v[148:151], v[16:31]
ds_read_b64_tr_b16 v[72:73], v10 offset:28672
ds_read_b64_tr_b16 v[74:75], v10 offset:29184
s_waitcnt lgkmcnt(6)
v_mfma_f32_32x32x16_bf16 v[16:31], v[56:59], v[152:155], v[16:31]
ds_read_b64_tr_b16 v[76:77], v10 offset:30720
ds_read_b64_tr_b16 v[78:79], v10 offset:31232
v_mfma_f32_32x32x16_bf16 v[16:31], v[60:63], v[156:159], v[16:31]
s_waitcnt vmcnt(4)
s_barrier
ds_read_b64_tr_b16 v[48:49], v10 offset:40960
ds_read_b64_tr_b16 v[50:51], v10 offset:41472
s_waitcnt lgkmcnt(6)
v_mfma_f32_32x32x16_bf16 v[16:31], v[64:67], v[160:163], v[16:31]
ds_read_b64_tr_b16 v[52:53], v10 offset:43008
ds_read_b64_tr_b16 v[54:55], v10 offset:43520
v_mfma_f32_32x32x16_bf16 v[16:31], v[68:71], v[164:167], v[16:31]
ds_read_b64_tr_b16 v[56:57], v10 offset:45056
ds_read_b64_tr_b16 v[58:59], v10 offset:45568
s_waitcnt lgkmcnt(6)
v_mfma_f32_32x32x16_bf16 v[16:31], v[72:75], v[168:171], v[16:31]
ds_read_b64_tr_b16 v[60:61], v10 offset:47104
ds_read_b64_tr_b16 v[62:63], v10 offset:47616
v_mfma_f32_32x32x16_bf16 v[16:31], v[76:79], v[172:175], v[16:31]
s_waitcnt vmcnt(0)
v_cmp_ne_u32 vcc, v246, v249
s_cbranch_vccnz Lvp_7
Lvpb_8:
s_add_u32 m0, s14, 8192
s_nop 0
buffer_load_dwordx4 v2, s[32:35], s10 offen offset:0 sc1 lds
buffer_load_dwordx4 v2, s[32:35], s10 offen offset:1024 sc1 lds
buffer_load_dwordx4 v2, s[32:35], s10 offen offset:2048 sc1 lds
buffer_load_dwordx4 v2, s[32:35], s10 offen offset:3072 sc1 lds
s_add_u32 s10, s10, 2097152
s_add_u32 s12, s12, 131072
ds_read_b64_tr_b16 v[64:65], v10 offset:49152
ds_read_b64_tr_b16 v[66:67], v10 offset:49664
s_waitcnt lgkmcnt(6)
v_mfma_f32_32x32x16_bf16 v[16:31], v[48:51], v[176:179], v[16:31]
ds_read_b64_tr_b16 v[68:69], v10 offset:51200
ds_read_b64_tr_b16 v[70:71], v10 offset:51712
v_mfma_f32_32x32x16_bf16 v[16:31], v[52:55], v[180:183], v[16:31]
ds_read_b64_tr_b16 v[72:73], v10 offset:53248
ds_read_b64_tr_b16 v[74:75], v10 offset:53760
s_waitcnt lgkmcnt(6)
v_mfma_f32_32x32x16_bf16 v[16:31], v[56:59], v[184:187], v[16:31]
ds_read_b64_tr_b16 v[76:77], v10 offset:55296
ds_read_b64_tr_b16 v[78:79], v10 offset:55808
v_mfma_f32_32x32x16_bf16 v[16:31], v[60:63], v[188:191], v[16:31]
buffer_store_dword v246, v254, s[32:35], s6 offen sc1
s_barrier
ds_read_b64_tr_b16 v[48:49], v11 offset:0
ds_read_b64_tr_b16 v[50:51], v11 offset:512
s_waitcnt lgkmcnt(6)
v_mfma_f32_32x32x16_bf16 v[16:31], v[64:67], v[192:195], v[16:31]
ds_read_b64_tr_b16 v[52:53], v11 offset:2048
ds_read_b64_tr_b16 v[54:55], v11 offset:2560
v_mfma_f32_32x32x16_bf16 v[16:31], v[68:71], v[196:199], v[16:31]
ds_read_b64_tr_b16 v[56:57], v11 offset:4096
ds_read_b64_tr_b16 v[58:59], v11 offset:4608
s_waitcnt lgkmcnt(6)
v_mfma_f32_32x32x16_bf16 v[16:31], v[72:75], v[200:203], v[16:31]
ds_read_b64_tr_b16 v[60:61], v11 offset:6144
ds_read_b64_tr_b16 v[62:63], v11 offset:6656
v_mfma_f32_32x32x16_bf16 v[16:31], v[76:79], v[204:207], v[16:31]
ds_read_b128 v[32:35], v103 offset:16384
ds_read_b128 v[36:39], v103 offset:17408
s_waitcnt lgkmcnt(6)
v_mfma_f32_32x32x16_bf16 v[16:31], v[48:51], v[208:211], v[16:31]
v_mfma_f32_32x32x16_bf16 v[16:31], v[52:55], v[212:215], v[16:31]
s_waitcnt lgkmcnt(2)
v_mfma_f32_32x32x16_bf16 v[16:31], v[56:59], v[216:219], v[16:31]
v_mfma_f32_32x32x16_bf16 v[16:31], v[60:63], v[220:223], v[16:31]
buffer_load_dword v250, v248, s[32:35], s12 offen sc1
s_nop 10
v_mul_f32 v240, 0xbfb8aa3b, v28
v_cvt_pk_bf16_f32 v224, v16, v17
v_cvt_pk_bf16_f32 v225, v18, v19
v_cvt_pk_bf16_f32 v226, v20, v21
v_cvt_pk_bf16_f32 v227, v22, v23
v_cvt_pk_bf16_f32 v228, v24, v25
v_cvt_pk_bf16_f32 v229, v26, v27
v_cvt_pk_bf16_f32 v230, v28, v29
v_cvt_pk_bf16_f32 v231, v30, v31
v_exp_f32 v240, v240
s_waitcnt lgkmcnt(0)
v_mfma_f32_32x32x16_bf16 v[64:79], v[32:35], v[224:227], 0
v_mfma_f32_32x32x16_bf16 v[64:79], v[36:39], v[228:231], v[64:79]
s_waitcnt vmcnt(2)
s_barrier
ds_read_b128 v[40:43], v103 offset:0
ds_read_b128 v[44:47], v103 offset:1024
ds_read_b128 v[168:171], v103 offset:14336
ds_read_b128 v[172:175], v103 offset:15360
ds_read_b128 v[176:179], v103 offset:12288
ds_read_b128 v[180:183], v103 offset:13312
ds_read_b128 v[184:187], v104 offset:16384
ds_read_b128 v[188:191], v104 offset:17408
s_waitcnt lgkmcnt(6)
v_mfma_f32_32x32x16_bf16 v[112:127], v[40:43], v[224:227], 0
v_mfma_f32_32x32x16_bf16 v[112:127], v[44:47], v[228:231], v[112:127]
s_mov_b32 s53, 0x21800000
v_mov_b32 v251, 0x5d800000
s_nop 9
v_cndmask_b32 v64, v64, v112, s[70:71]
v_cndmask_b32 v65, v65, v113, s[72:73]
v_cndmask_b32 v66, v66, v114, s[74:75]
v_cndmask_b32 v67, v67, v115, s[76:77]
v_cndmask_b32 v68, v68, v116, s[78:79]
v_cndmask_b32 v69, v69, v117, s[80:81]
v_cndmask_b32 v70, v70, v118, s[82:83]
v_cndmask_b32 v71, v71, v119, s[84:85]
v_cndmask_b32 v72, v72, v120, s[86:87]
v_cndmask_b32 v73, v73, v121, s[88:89]
v_cndmask_b32 v74, v74, v122, s[90:91]
v_cndmask_b32 v75, v75, v123, s[92:93]
v_cndmask_b32 v76, v76, v124, s[94:95]
v_cndmask_b32 v77, v77, v125, s[96:97]
v_cndmask_b32 v78, v78, v126, s[98:99]
v_cndmask_b32 v79, v79, v127, s[100:101]
v_max3_f32 v222, v64, v65, v66
v_max3_f32 v241, v67, v68, v69
v_max3_f32 v222, v70, v71, v222
v_max3_f32 v241, v72, v73, v241
v_max3_f32 v222, v74, v75, v222
v_max3_f32 v241, v76, v77, v241
v_max3_f32 v222, v78, v79, v222
v_max_f32 v242, v241, v222
v_max_f32 v222, v241, v222
s_nop 1
v_permlane32_swap_b32 v242, v222
v_max_f32 v222, v222, v242
v_sub_f32 v48, 0, v222
v_sub_f32 v49, 0, v222
v_pk_mov_b32 v[50:51], v[48:49], v[48:49] op_sel:[0,1]
v_pk_mov_b32 v[52:53], v[48:49], v[48:49] op_sel:[0,1]
v_pk_mov_b32 v[54:55], v[48:49], v[48:49] op_sel:[0,1]
v_pk_mov_b32 v[56:57], v[48:49], v[48:49] op_sel:[0,1]
v_pk_mov_b32 v[58:59], v[48:49], v[48:49] op_sel:[0,1]
v_pk_mov_b32 v[60:61], v[48:49], v[48:49] op_sel:[0,1]
v_pk_mov_b32 v[62:63], v[48:49], v[48:49] op_sel:[0,1]
v_pk_add_f32 v[64:65], v[64:65], v[48:49]
v_pk_add_f32 v[66:67], v[66:67], v[48:49]
v_pk_add_f32 v[68:69], v[68:69], v[48:49]
v_pk_add_f32 v[70:71], v[70:71], v[48:49]
v_pk_add_f32 v[72:73], v[72:73], v[48:49]
v_pk_add_f32 v[74:75], v[74:75], v[48:49]
v_pk_add_f32 v[76:77], v[76:77], v[48:49]
v_pk_add_f32 v[78:79], v[78:79], v[48:49]
s_waitcnt lgkmcnt(4)
v_mfma_f32_32x32x16_bf16 v[112:127], v[168:171], v[224:227], v[48:63]
v_exp_f32 v64, v64
v_exp_f32 v65, v65
v_mfma_f32_32x32x16_bf16 v[112:127], v[172:175], v[228:231], v[112:127]
ds_read_b128 v[168:171], v103 offset:10240
ds_read_b128 v[172:175], v103 offset:11264
v_exp_f32 v66, v66
v_exp_f32 v67, v67
v_exp_f32 v68, v68
s_waitcnt lgkmcnt(4)
v_mfma_f32_32x32x16_bf16 v[16:31], v[176:179], v[224:227], v[48:63]
v_exp_f32 v69, v69
v_exp_f32 v70, v70
v_mfma_f32_32x32x16_bf16 v[16:31], v[180:183], v[228:231], v[16:31]
ds_read_b128 v[176:179], v103 offset:8192
ds_read_b128 v[180:183], v103 offset:9216
v_exp_f32 v71, v71
v_exp_f32 v72, v72
v_exp_f32 v73, v73
s_waitcnt lgkmcnt(2)
v_mfma_f32_32x32x16_bf16 v[32:47], v[168:171], v[224:227], v[48:63]
v_exp_f32 v74, v74
v_exp_f32 v75, v75
v_mfma_f32_32x32x16_bf16 v[32:47], v[172:175], v[228:231], v[32:47]
ds_read_b128 v[168:171], v103 offset:6144
ds_read_b128 v[172:175], v103 offset:7168
v_exp_f32 v76, v76
v_exp_f32 v77, v77
v_exp_f32 v78, v78
v_exp_f32 v79, v79
v_cvt_pk_bf16_f32 v144, v64, v65
v_cvt_pk_bf16_f32 v145, v66, v67
v_cvt_pk_bf16_f32 v146, v68, v69
v_cvt_pk_bf16_f32 v147, v70, v71
v_cvt_pk_bf16_f32 v148, v72, v73
v_cvt_pk_bf16_f32 v149, v74, v75
v_cvt_pk_bf16_f32 v150, v76, v77
v_cvt_pk_bf16_f32 v151, v78, v79
v_and_b32 v160, v144, v94
v_and_b32 v161, v145, v95
v_and_b32 v162, v146, v96
v_and_b32 v163, v147, v97
v_and_b32 v164, v148, v98
v_and_b32 v165, v149, v99
v_and_b32 v166, v150, v100
v_and_b32 v167, v151, v101
v_xor_b32 v144, v144, v160
v_xor_b32 v145, v145, v161
v_xor_b32 v146, v146, v162
v_xor_b32 v147, v147, v163
v_xor_b32 v148, v148, v164
v_xor_b32 v149, v149, v165
v_xor_b32 v150, v150, v166
v_xor_b32 v151, v151, v167
v_mfma_f32_32x32x16_bf16 v[128:143], v[184:187], v[144:147], 0
s_nop 0
v_mfma_f32_32x32x16_bf16 v[128:143], v[188:191], v[148:151], v[128:143]
s_waitcnt lgkmcnt(2)
v_mfma_f32_32x32x16_bf16 v[64:79], v[176:179], v[224:227], v[48:63]
v_exp_f32 v112, v112
v_exp_f32 v113, v113
v_exp_f32 v114, v114
v_exp_f32 v115, v115
v_mfma_f32_32x32x16_bf16 v[64:79], v[180:183], v[228:231], v[64:79]
ds_read_b128 v[176:179], v103 offset:4096
ds_read_b128 v[180:183], v103 offset:5120
s_waitcnt vmcnt(0)
v_cmp_ne_u32 vcc, v246, v250
s_cbranch_vccnz Lvp_9
Lvpb_10:
s_add_u32 m0, s14, 57344
s_nop 0
buffer_load_dwordx4 v2, s[32:35], s10 offen offset:0 sc1 lds
buffer_load_dwordx4 v2, s[32:35], s10 offen offset:1024 sc1 lds
buffer_load_dwordx4 v2, s[32:35], s10 offen offset:2048 sc1 lds
buffer_load_dwordx4 v2, s[32:35], s10 offen offset:3072 sc1 lds
s_add_u32 m0, s67, 122880
s_add_u32 s52, s26, 114688
buffer_load_dwordx4 v3, s[40:43], s52 offen lds
v_exp_f32 v116, v116
v_exp_f32 v117, v117
v_exp_f32 v118, v118
v_exp_f32 v119, v119
v_cvt_pk_bf16_f32 v152, v112, v113
v_cvt_pk_bf16_f32 v153, v114, v115
v_cvt_pk_bf16_f32 v154, v116, v117
v_cvt_pk_bf16_f32 v155, v118, v119
v_exp_f32 v120, v120
v_exp_f32 v121, v121
s_add_u32 m0, s67, 139264
s_add_u32 s52, s26, 229376
buffer_load_dwordx4 v3, s[40:43], s52 offen lds
v_exp_f32 v122, v122
v_exp_f32 v123, v123
v_cvt_pk_bf16_f32 v156, v120, v121
v_cvt_pk_bf16_f32 v157, v122, v123
v_exp_f32 v124, v124
v_exp_f32 v125, v125
v_exp_f32 v126, v126
v_exp_f32 v127, v127
v_cvt_pk_bf16_f32 v158, v124, v125
v_cvt_pk_bf16_f32 v159, v126, v127
s_waitcnt lgkmcnt(2)
v_mfma_f32_32x32x16_bf16 v[112:127], v[168:171], v[224:227], v[48:63]
v_exp_f32 v16, v16
v_exp_f32 v17, v17
v_exp_f32 v18, v18
v_exp_f32 v19, v19
v_mfma_f32_32x32x16_bf16 v[112:127], v[172:175], v[228:231], v[112:127]
ds_read_b128 v[168:171], v103 offset:2048
ds_read_b128 v[172:175], v103 offset:3072
s_add_u32 m0, s67, 147456
s_add_u32 s52, s26, 286720
buffer_load_dwordx4 v3, s[40:43], s52 offen lds
v_exp_f32 v20, v20
v_exp_f32 v21, v21
v_exp_f32 v22, v22
v_exp_f32 v23, v23
v_cvt_pk_bf16_f32 v144, v16, v17
v_cvt_pk_bf16_f32 v145, v18, v19
v_cvt_pk_bf16_f32 v146, v20, v21
v_cvt_pk_bf16_f32 v147, v22, v23
v_exp_f32 v24, v24
v_exp_f32 v25, v25
s_add_u32 m0, s67, 155648
s_add_u32 s52, s26, 344064
buffer_load_dwordx4 v3, s[40:43], s52 offen lds
v_exp_f32 v26, v26
v_exp_f32 v27, v27
v_cvt_pk_bf16_f32 v148, v24, v25
v_cvt_pk_bf16_f32 v149, v26, v27
v_exp_f32 v28, v28
v_exp_f32 v29, v29
v_exp_f32 v30, v30
v_exp_f32 v31, v31
v_cvt_pk_bf16_f32 v150, v28, v29
v_cvt_pk_bf16_f32 v151, v30, v31
s_waitcnt lgkmcnt(2)
v_mfma_f32_32x32x16_bf16 v[16:31], v[176:179], v[224:227], v[48:63]
v_exp_f32 v32, v32
v_exp_f32 v33, v33
v_exp_f32 v34, v34
v_exp_f32 v35, v35
v_mfma_f32_32x32x16_bf16 v[16:31], v[180:183], v[228:231], v[16:31]
v_exp_f32 v36, v36
v_exp_f32 v37, v37
v_exp_f32 v38, v38
v_exp_f32 v39, v39
v_cvt_pk_bf16_f32 v208, v32, v33
v_cvt_pk_bf16_f32 v209, v34, v35
v_cvt_pk_bf16_f32 v210, v36, v37
v_cvt_pk_bf16_f32 v211, v38, v39
v_exp_f32 v40, v40
v_exp_f32 v41, v41
v_exp_f32 v42, v42
v_exp_f32 v43, v43
v_cvt_pk_bf16_f32 v212, v40, v41
v_cvt_pk_bf16_f32 v213, v42, v43
v_exp_f32 v44, v44
v_exp_f32 v45, v45
v_exp_f32 v46, v46
v_exp_f32 v47, v47
v_cvt_pk_bf16_f32 v214, v44, v45
v_cvt_pk_bf16_f32 v215, v46, v47
s_waitcnt lgkmcnt(0)
v_mfma_f32_32x32x16_bf16 v[32:47], v[168:171], v[224:227], v[48:63]
v_exp_f32 v64, v64
v_exp_f32 v65, v65
v_exp_f32 v66, v66
v_exp_f32 v67, v67
v_mfma_f32_32x32x16_bf16 v[32:47], v[172:175], v[228:231], v[32:47]
s_waitcnt vmcnt(4)
s_barrier
ds_read_b128 v[184:187], v104 offset:0
ds_read_b128 v[188:191], v104 offset:1024
ds_read_b128 v[192:195], v104 offset:14336
ds_read_b128 v[196:199], v104 offset:15360
ds_read_b128 v[176:179], v104 offset:12288
ds_read_b128 v[180:183], v104 offset:13312
ds_read_b128 v[200:203], v104 offset:10240
ds_read_b128 v[204:207], v104 offset:11264
s_add_u32 m0, s67, 106496
s_nop 0
buffer_load_dwordx4 v3, s[40:43], s26 offen lds
s_add_u32 m0, s67, 114688
s_add_u32 s52, s26, 57344
buffer_load_dwordx4 v3, s[40:43], s52 offen lds
v_exp_f32 v68, v68
v_exp_f32 v69, v69
v_exp_f32 v70, v70
v_exp_f32 v71, v71
v_cvt_pk_bf16_f32 v168, v64, v65
v_cvt_pk_bf16_f32 v169, v66, v67
v_cvt_pk_bf16_f32 v170, v68, v69
v_cvt_pk_bf16_f32 v171, v70, v71
s_waitcnt lgkmcnt(6)
v_mfma_f32_32x32x16_bf16 v[128:143], v[184:187], v[160:163], v[128:143]
v_exp_f32 v72, v72
v_exp_f32 v73, v73
v_mfma_f32_32x32x16_bf16 v[128:143], v[188:191], v[164:167], v[128:143]
s_add_u32 m0, s67, 131072
s_add_u32 s52, s26, 172032
buffer_load_dwordx4 v3, s[40:43], s52 offen lds
s_add_u32 m0, s67, 0
s_nop 0
buffer_load_dwordx4 v3, s[44:47], s26 offen lds
v_exp_f32 v74, v74
v_exp_f32 v75, v75
v_cvt_pk_bf16_f32 v172, v72, v73
v_cvt_pk_bf16_f32 v173, v74, v75
s_waitcnt lgkmcnt(4)
v_mfma_f32_32x32x16_bf16 v[128:143], v[192:195], v[152:155], v[128:143]
v_exp_f32 v76, v76
v_exp_f32 v77, v77
v_exp_f32 v78, v78
v_exp_f32 v79, v79
v_mfma_f32_32x32x16_bf16 v[128:143], v[196:199], v[156:159], v[128:143]
v_cvt_pk_bf16_f32 v174, v76, v77
v_cvt_pk_bf16_f32 v175, v78, v79
s_waitcnt lgkmcnt(2)
v_mfma_f32_32x32x16_bf16 v[128:143], v[176:179], v[144:147], v[128:143]
ds_read_b128 v[184:187], v104 offset:8192
ds_read_b128 v[188:191], v104 offset:9216
ds_read_b128 v[192:195], v104 offset:6144
ds_read_b128 v[196:199], v104 offset:7168
v_exp_f32 v112, v112
v_exp_f32 v113, v113
v_exp_f32 v114, v114
v_exp_f32 v115, v115
v_mfma_f32_32x32x16_bf16 v[128:143], v[180:183], v[148:151], v[128:143]
s_add_u32 m0, s67, 8192
s_add_u32 s52, s26, 57344
buffer_load_dwordx4 v3, s[44:47], s52 offen lds
s_add_u32 m0, s67, 16384
s_add_u32 s52, s26, 114688
buffer_load_dwordx4 v3, s[44:47], s52 offen lds
v_exp_f32 v116, v116
v_exp_f32 v117, v117
v_exp_f32 v118, v118
v_exp_f32 v119, v119
v_cvt_pk_bf16_f32 v160, v112, v113
v_cvt_pk_bf16_f32 v161, v114, v115
v_cvt_pk_bf16_f32 v162, v116, v117
v_cvt_pk_bf16_f32 v163, v118, v119
v_exp_f32 v120, v120
v_exp_f32 v121, v121
s_waitcnt lgkmcnt(4)
v_mfma_f32_32x32x16_bf16 v[128:143], v[200:203], v[208:211], v[128:143]
s_add_u32 m0, s67, 24576
s_add_u32 s52, s26, 172032
buffer_load_dwordx4 v3, s[44:47], s52 offen lds
s_add_u32 m0, s67, 32768
s_add_u32 s52, s26, 229376
buffer_load_dwordx4 v3, s[44:47], s52 offen lds
v_exp_f32 v122, v122
v_exp_f32 v123, v123
v_cvt_pk_bf16_f32 v164, v120, v121
v_cvt_pk_bf16_f32 v165, v122, v123
v_mfma_f32_32x32x16_bf16 v[128:143], v[204:207], v[212:215], v[128:143]
v_exp_f32 v124, v124
v_exp_f32 v125, v125
v_exp_f32 v126, v126
v_exp_f32 v127, v127
v_cvt_pk_bf16_f32 v166, v124, v125
v_cvt_pk_bf16_f32 v167, v126, v127
s_waitcnt lgkmcnt(2)
v_mfma_f32_32x32x16_bf16 v[128:143], v[184:187], v[168:171], v[128:143]
ds_read_b128 v[176:179], v104 offset:4096
ds_read_b128 v[180:183], v104 offset:5120
ds_read_b128 v[200:203], v104 offset:2048
ds_read_b128 v[204:207], v104 offset:3072
v_exp_f32 v16, v16
v_exp_f32 v17, v17
v_exp_f32 v18, v18
v_exp_f32 v19, v19
v_mfma_f32_32x32x16_bf16 v[128:143], v[188:191], v[172:175], v[128:143]
s_add_u32 m0, s67, 40960
s_add_u32 s52, s26, 286720
buffer_load_dwordx4 v3, s[44:47], s52 offen lds
s_add_u32 m0, s67, 49152
s_add_u32 s52, s26, 344064
buffer_load_dwordx4 v3, s[44:47], s52 offen lds
v_exp_f32 v20, v20
v_exp_f32 v21, v21
v_exp_f32 v22, v22
v_exp_f32 v23, v23
v_cvt_pk_bf16_f32 v152, v16, v17
v_cvt_pk_bf16_f32 v153, v18, v19
v_cvt_pk_bf16_f32 v154, v20, v21
v_cvt_pk_bf16_f32 v155, v22, v23
v_exp_f32 v24, v24
v_exp_f32 v25, v25
s_waitcnt lgkmcnt(4)
v_mfma_f32_32x32x16_bf16 v[128:143], v[192:195], v[160:163], v[128:143]
v_exp_f32 v26, v26
v_exp_f32 v27, v27
v_cvt_pk_bf16_f32 v156, v24, v25
v_cvt_pk_bf16_f32 v157, v26, v27
v_mfma_f32_32x32x16_bf16 v[128:143], v[196:199], v[164:167], v[128:143]
v_exp_f32 v28, v28
v_exp_f32 v29, v29
v_exp_f32 v30, v30
v_exp_f32 v31, v31
v_cvt_pk_bf16_f32 v158, v28, v29
v_cvt_pk_bf16_f32 v159, v30, v31
s_waitcnt lgkmcnt(2)
v_mfma_f32_32x32x16_bf16 v[128:143], v[176:179], v[152:155], v[128:143]
v_exp_f32 v32, v32
v_exp_f32 v33, v33
v_exp_f32 v34, v34
v_exp_f32 v35, v35
v_mfma_f32_32x32x16_bf16 v[128:143], v[180:183], v[156:159], v[128:143]
v_exp_f32 v36, v36
v_exp_f32 v37, v37
v_exp_f32 v38, v38
v_exp_f32 v39, v39
v_cvt_pk_bf16_f32 v144, v32, v33
v_cvt_pk_bf16_f32 v145, v34, v35
v_cvt_pk_bf16_f32 v146, v36, v37
v_cvt_pk_bf16_f32 v147, v38, v39
v_exp_f32 v40, v40
v_exp_f32 v41, v41
s_waitcnt lgkmcnt(0)
v_mfma_f32_32x32x16_bf16 v[128:143], v[200:203], v[144:147], v[128:143]
v_exp_f32 v42, v42
v_exp_f32 v43, v43
v_cvt_pk_bf16_f32 v148, v40, v41
v_cvt_pk_bf16_f32 v149, v42, v43
v_exp_f32 v44, v44
v_exp_f32 v45, v45
v_exp_f32 v46, v46
v_exp_f32 v47, v47
v_cvt_pk_bf16_f32 v150, v44, v45
v_cvt_pk_bf16_f32 v151, v46, v47
s_nop 1
v_mfma_f32_32x32x16_bf16 v[128:143], v[204:207], v[148:151], v[128:143]
s_nop 11
v_med3_f32 v241, v140, s53, v251
v_cmp_neq_f32 vcc, v241, v140
s_cmp_lg_u32 vcc_hi, 0
s_cbranch_scc1 L_att_fb
L_att_ok:
s_nop 5
v_fma_f32 v241, v140, v240, v140
v_rcp_f32 v241, v241
s_nop 0
v_mov_b32 v242, v241
s_nop 1
v_permlane32_swap_b32 v241, v242
v_cndmask_b32 v140, v140, v135, s[60:61]
v_permlane32_swap_b32 v142, v143
v_permlane32_swap_b32 v141, v135
v_pk_mul_f32 v[128:129], v[128:129], v[242:243] op_sel_hi:[1,0]
v_pk_mul_f32 v[130:131], v[130:131], v[242:243] op_sel_hi:[1,0]
v_pk_mul_f32 v[132:133], v[132:133], v[242:243] op_sel_hi:[1,0]
v_pk_mul_f32 v[134:135], v[134:135], v[242:243] op_sel_hi:[1,0]
v_cvt_pk_bf16_f32 v232, v128, v129
v_cvt_pk_bf16_f32 v233, v130, v131
v_cvt_pk_bf16_f32 v234, v132, v133
v_cvt_pk_bf16_f32 v235, v134, v5
buffer_store_dwordx4 v[232:235], v2, s[32:35], s8 offen offset:0 sc1
v_pk_mul_f32 v[136:137], v[136:137], v[242:243] op_sel_hi:[1,0]
v_pk_mul_f32 v[138:139], v[138:139], v[242:243] op_sel_hi:[1,0]
v_pk_mul_f32 v[140:141], v[140:141], v[242:243] op_sel_hi:[1,0]
v_pk_mul_f32 v[142:143], v[142:143], v[242:243] op_sel_hi:[1,0]
v_cvt_pk_bf16_f32 v236, v136, v137
v_cvt_pk_bf16_f32 v237, v138, v139
v_cvt_pk_bf16_f32 v238, v140, v141
v_cvt_pk_bf16_f32 v239, v142, v5
buffer_store_dwordx4 v[236:239], v2, s[32:35], s8 offen offset:1024 sc1
buffer_store_dword v246, v254, s[32:35], s9 offen sc1
s_cmp_eq_u32 s27, 1
s_cbranch_scc1 L_done
s_load_dword s28, s[24:25], 0 glc
s_load_dword s29, s[24:25], 128 glc
s_load_dword s30, s[24:25], 256 glc
s_load_dword s31, s[24:25], 384 glc
s_waitcnt vmcnt(3)
s_barrier
s_branch L_p3
L_att_fb:
s_sub_u32 s68, 8, s64
s_mov_b32 s55, 0
v_mov_b32 v222, 0xff61b1e6
v_mov_b32 v243, 0xff61b1e6
v_mov_b32 v128, 0
v_mov_b32 v129, 0
v_mov_b32 v130, 0
v_mov_b32 v131, 0
v_mov_b32 v132, 0
v_mov_b32 v133, 0
v_mov_b32 v134, 0
v_mov_b32 v135, 0
v_mov_b32 v136, 0
v_mov_b32 v137, 0
v_mov_b32 v138, 0
v_mov_b32 v139, 0
v_mov_b32 v140, 0
v_mov_b32 v141, 0
v_mov_b32 v142, 0
v_mov_b32 v143, 0
L_fb_pass:
s_max_i32 s54, s68, 0
L_fb_tile:
s_lshl_b32 s69, s62, 6
s_add_u32 s69, s69, s64
s_add_u32 s69, s69, s54
s_sub_u32 s69, s69, 8
s_lshl_b32 s69, s69, 11
s_add_u32 s69, s69, 0
buffer_load_dwordx4 v[168:171], v2, s[32:35], s69 offen sc1
buffer_load_dwordx4 v[172:175], v2, s[32:35], s69 offen offset:1024 sc1
s_lshl_b32 s69, s54, 11
v_add_u32 v244, s69, v104
ds_read_b128 v[184:187], v244
ds_read_b128 v[188:191], v244 offset:1024
s_waitcnt vmcnt(0) lgkmcnt(0)
v_mfma_f32_32x32x16_bf16 v[64:79], v[168:171], v[224:227], 0
v_mfma_f32_32x32x16_bf16 v[64:79], v[172:175], v[228:231], v[64:79]
s_cmp_eq_u32 s54, 0
s_cbranch_scc0 L_fb_n0
s_nop 9
v_cndmask_b32 v64, v243, v64, s[70:71]
v_cndmask_b32 v65, v243, v65, s[72:73]
v_cndmask_b32 v66, v243, v66, s[74:75]
v_cndmask_b32 v67, v243, v67, s[76:77]
v_cndmask_b32 v68, v243, v68, s[78:79]
v_cndmask_b32 v69, v243, v69, s[80:81]
v_cndmask_b32 v70, v243, v70, s[82:83]
v_cndmask_b32 v71, v243, v71, s[84:85]
v_cndmask_b32 v72, v243, v72, s[86:87]
v_cndmask_b32 v73, v243, v73, s[88:89]
v_cndmask_b32 v74, v243, v74, s[90:91]
v_cndmask_b32 v75, v243, v75, s[92:93]
v_cndmask_b32 v76, v243, v76, s[94:95]
v_cndmask_b32 v77, v243, v77, s[96:97]
v_cndmask_b32 v78, v243, v78, s[98:99]
v_cndmask_b32 v79, v243, v79, s[100:101]
L_fb_n0:
s_cmp_eq_u32 s54, 8
s_cbranch_scc0 L_fb_n8
s_nop 7
v_cndmask_b32 v64, v64, v243, s[70:71]
v_cndmask_b32 v65, v65, v243, s[72:73]
v_cndmask_b32 v66, v66, v243, s[74:75]
v_cndmask_b32 v67, v67, v243, s[76:77]
v_cndmask_b32 v68, v68, v243, s[78:79]
v_cndmask_b32 v69, v69, v243, s[80:81]
v_cndmask_b32 v70, v70, v243, s[82:83]
v_cndmask_b32 v71, v71, v243, s[84:85]
v_cndmask_b32 v72, v72, v243, s[86:87]
v_cndmask_b32 v73, v73, v243, s[88:89]
v_cndmask_b32 v74, v74, v243, s[90:91]
v_cndmask_b32 v75, v75, v243, s[92:93]
v_cndmask_b32 v76, v76, v243, s[94:95]
v_cndmask_b32 v77, v77, v243, s[96:97]
v_cndmask_b32 v78, v78, v243, s[98:99]
v_cndmask_b32 v79, v79, v243, s[100:101]
L_fb_n8:
s_cmp_eq_u32 s55, 0
s_cbranch_scc0 L_fb_p1
s_nop 5
v_max3_f32 v222, v64, v65, v222
v_max3_f32 v222, v66, v67, v222
v_max3_f32 v222, v68, v69, v222
v_max3_f32 v222, v70, v71, v222
v_max3_f32 v222, v72, v73, v222
v_max3_f32 v222, v74, v75, v222
v_max3_f32 v222, v76, v77, v222
v_max3_f32 v222, v78, v79, v222
s_branch L_fb_next
L_fb_p1:
s_nop 5
v_sub_f32 v64, v64, v222
v_sub_f32 v65, v65, v222
v_sub_f32 v66, v66, v222
v_sub_f32 v67, v67, v222
v_sub_f32 v68, v68, v222
v_sub_f32 v69, v69, v222
v_sub_f32 v70, v70, v222
v_sub_f32 v71, v71, v222
v_sub_f32 v72, v72, v222
v_sub_f32 v73, v73, v222
v_sub_f32 v74, v74, v222
v_sub_f32 v75, v75, v222
v_sub_f32 v76, v76, v222
v_sub_f32 v77, v77, v222
v_sub_f32 v78, v78, v222
v_sub_f32 v79, v79, v222
v_exp_f32 v64, v64
v_exp_f32 v65, v65
v_exp_f32 v66, v66
v_exp_f32 v67, v67
v_exp_f32 v68, v68
v_exp_f32 v69, v69
v_exp_f32 v70, v70
v_exp_f32 v71, v71
v_exp_f32 v72, v72
v_exp_f32 v73, v73
v_exp_f32 v74, v74
v_exp_f32 v75, v75
v_exp_f32 v76, v76
v_exp_f32 v77, v77
v_exp_f32 v78, v78
v_exp_f32 v79, v79
v_cvt_pk_bf16_f32 v144, v64, v65
v_cvt_pk_bf16_f32 v145, v66, v67
v_cvt_pk_bf16_f32 v146, v68, v69
v_cvt_pk_bf16_f32 v147, v70, v71
v_cvt_pk_bf16_f32 v148, v72, v73
v_cvt_pk_bf16_f32 v149, v74, v75
v_cvt_pk_bf16_f32 v150, v76, v77
v_cvt_pk_bf16_f32 v151, v78, v79
v_mfma_f32_32x32x16_bf16 v[128:143], v[184:187], v[144:147], v[128:143]
s_nop 0
v_mfma_f32_32x32x16_bf16 v[128:143], v[188:191], v[148:151], v[128:143]
L_fb_next:
s_add_u32 s54, s54, 1
s_cmp_le_u32 s54, 8
s_cbranch_scc1 L_fb_tile
s_cmp_eq_u32 s55, 1
s_cbranch_scc1 L_fb_done
s_mov_b32 s55, 1
v_mov_b32 v242, v222
s_nop 1
v_permlane32_swap_b32 v242, v222
v_max_f32 v222, v222, v242
s_branch L_fb_pass
L_fb_done:
s_branch L_att_ok
L_typeB:
s_lshl_b32 s101, s63, 7
s_add_u32 s101, s101, s65
s_add_u32 m0, s67, 0
s_nop 0
buffer_load_dwordx4 v3, s[24:27], s101 offen lds
s_add_u32 m0, s67, 8192
s_add_u32 s52, s101, 57344
buffer_load_dwordx4 v3, s[24:27], s52 offen lds
s_mul_i32 s0, s63, 172032
s_add_u32 s0, s0, s100
s_add_u32 m0, s67, 114688
s_add_u32 s52, s0, 896
buffer_load_dwordx4 v4, s[28:31], s52 offen lds
s_mov_b32 s40, s14
s_mov_b32 s41, s15
s_mov_b32 s42, 401408
s_mov_b32 s43, 0x20000
s_mov_b32 s44, s8
s_mov_b32 s45, s9
s_mov_b32 s46, 401408
s_mov_b32 s47, 0x20000
s_lshl_b32 s62, s60, 1
s_add_u32 s62, s62, s58
s_lshl_b32 s64, s59, 2
s_add_u32 s64, s64, s57
v_and_b32 v9, 31, v1
v_lshrrev_b32 v10, 5, v1
v_bfe_u32 v11, v1, 1, 3
s_lshl_b32 s53, s57, 12
v_lshl_add_u32 v9, v9, 7, s53
v_add_u32 v15, 0, v10
v_xor_b32 v15, v15, v11
v_lshl_add_u32 v5, v15, 4, v9
v_add_u32 v15, 2, v10
v_xor_b32 v15, v15, v11
v_lshl_add_u32 v6, v15, 4, v9
v_add_u32 v15, 4, v10
v_xor_b32 v15, v15, v11
v_lshl_add_u32 v7, v15, 4, v9
v_add_u32 v15, 6, v10
v_xor_b32 v15, v15, v11
v_lshl_add_u32 v8, v15, 4, v9
v_bfe_u32 v241, v1, 4, 1
v_and_b32 v242, 3, v1
v_lshlrev_b32 v241, 5, v241
v_lshl_add_u32 v241, v242, 3, v241
s_mul_i32 s53, s58, 56
v_cmp_eq_u32 s[54:55], 56, v241
v_add_u32 v241, s53, v241
v_mov_b32 v242, 112
v_cndmask_b32 v241, v241, v242, s[54:55]
v_bfe_u32 v242, v1, 2, 2
v_and_b32 v243, 2, v242
v_lshlrev_b32 v243, 5, v243
v_xor_b32 v241, v241, v243
v_lshl_add_u32 v242, v10, 3, v242
v_lshl_add_u32 v9, v242, 7, v241
v_add_u32 v10, 0x10000, v9
v_add_u32 v11, 0x20000, v9
s_lshr_b32 s53, s2, 3
s_or_b32 s53, s53, s56
s_cbranch_scc1 Lnn_11
s_memrealtime s[54:55]
s_waitcnt lgkmcnt(0)
s_or_b32 s54, s54, 1
v_mov_b32 v242, s54
v_mov_b32 v243, 0
s_mov_b64 exec, 1
global_atomic_cmpswap v243, v[242:243], s[20:21] sc1
s_mov_b64 exec, -1
Lnn_11:
s_add_u32 s22, s22, 251658240
s_addc_u32 s23, s23, 0
s_mov_b32 s32, s22
s_mov_b32 s33, s23
s_mov_b32 s34, 12582912
s_mov_b32 s35, 0x20000
s_mov_b32 s36, s16
s_mov_b32 s37, s17
s_mov_b32 s38, 896
s_mov_b32 s39, 0x20000
v_lshrrev_b32 v242, 3, v1
v_add_u32 v242, s68, v242
v_subrev_u32 v15, 7, v242
v_min_u32 v242, v242, v15
v_lshlrev_b32 v15, 7, v242
v_and_b32 v241, 7, v1
v_lshl_add_u32 v15, v241, 1, v15
s_lshl_b32 s52, s56, 4
buffer_load_ushort v12, v15, s[36:39], s52 offen
s_mov_b32 s48, s18
s_mov_b32 s49, s19
s_mov_b32 s50, 1835008
s_mov_b32 s51, 0x20000
s_mov_b32 s38, 0xF7F77F7F
s_mov_b32 s39, 0xF7F77F7F
s_lshr_b32 s55, s2, 4
s_cmp_eq_u32 s61, 0
s_cselect_b32 s68, 16, 0
s_add_u32 s55, s55, s68
s_mul_i32 s53, s55, 37
s_lshr_b32 s53, s53, 8
s_mul_i32 s54, s53, 7
s_sub_u32 s68, s55, s54
s_cmp_ge_u32 s55, 28
s_cselect_b32 s69, 1, 0
s_cselect_b32 s68, 0, s68
s_cselect_b32 s53, 0, s53
s_and_b32 s54, s2, 7
s_lshl_b32 s54, s54, 2
s_add_u32 s53, s53, s54
s_lshl_b32 s53, s53, 1
s_add_u32 s53, s53, s58
s_mul_i32 s37, s53, 28672
s_lshl_b32 s68, s68, 7
s_add_u32 s37, s37, s68
s_lshl_b32 s54, s57, 5
s_add_u32 s37, s37, s54
s_lshl_b32 s53, s53, 2
s_add_u32 s53, s53, s57
s_lshl_b32 s53, s53, 2
s_mul_i32 s36, s53, 128
s_add_u32 s36, s36, 9830400
s_lshl_b32 s53, s53, 11
s_bfe_u32 s54, s68, 0x10007
s_lshl_b32 s54, s54, 12
s_add_u32 s53, s53, s54
s_xor_b32 s54, s53, 4096
s_add_u32 s16, s53, 6291456
s_add_u32 s17, s54, 6291456
s_add_u32 s18, s53, 4194304
s_add_u32 s19, s54, 4194304
s_mul_i32 s10, s56, 7168
s_add_u32 s10, s10, s68
s_mov_b32 s15, s69
s_lshl_b32 s54, s64, 4
s_add_u32 s54, s54, s62
s_cmp_eq_u32 s61, 0
s_cselect_b32 s53, 0, 2097152
s_cselect_b32 s55, 0, 131072
s_lshl_b32 s8, s54, 11
s_add_u32 s8, s8, s53
s_add_u32 s8, s8, 4194304
s_mul_i32 s9, s54, 128
s_add_u32 s9, s9, s55
s_add_u32 s9, s9, 9699328
v_lshlrev_b32 v254, 24, v1
v_mov_b32 v13, 0
v_and_b32 v241, 7, v1
v_lshlrev_b32 v14, 7, v241
v_and_b32 v241, 2, v241
v_lshlrev_b32 v241, 5, v241
v_xor_b32 v241, 112, v241
v_add3_u32 v14, v14, v241, s67
v_lshrrev_b32 v241, 3, v1
v_lshl_add_u32 v14, v241, 13, v14
v_lshrrev_b32 v241, 4, v1
v_lshl_add_u32 v14, v241, 13, v14
v_add_u32 v14, 57344, v14
s_add_u32 s63, s63, 1
s_cmp_eq_u32 s63, 7
s_cselect_b32 s63, 0, s63
s_lshl_b32 s101, s63, 7
s_add_u32 s101, s101, s65
s_add_u32 m0, s67, 16384
s_nop 0
buffer_load_dwordx4 v3, s[24:27], s101 offen lds
s_add_u32 m0, s67, 24576
s_add_u32 s52, s101, 57344
buffer_load_dwordx4 v3, s[24:27], s52 offen lds
s_mul_i32 s1, s63, 172032
s_add_u32 s1, s1, s100
s_add_u32 m0, s67, 122880
s_add_u32 s52, s1, 896
buffer_load_dwordx4 v4, s[28:31], s52 offen lds
s_waitcnt vmcnt(4)
s_barrier
ds_read_b128 v[112:115], v5 offset:0
ds_read_b64_tr_b16 v[48:49], v10 offset:49152
ds_read_b64_tr_b16 v[50:51], v10 offset:49664
s_add_u32 s63, s63, 1
s_cmp_eq_u32 s63, 7
s_cselect_b32 s63, 0, s63
s_lshl_b32 s101, s63, 7
s_add_u32 s101, s101, s65
s_add_u32 m0, s67, 32768
s_nop 0
buffer_load_dwordx4 v3, s[24:27], s101 offen lds
s_add_u32 m0, s67, 40960
s_add_u32 s52, s101, 57344
buffer_load_dwordx4 v3, s[24:27], s52 offen lds
s_mul_i32 s66, s63, 172032
s_add_u32 s66, s66, s100
s_add_u32 m0, s67, 131072
s_add_u32 s52, s66, 896
buffer_load_dwordx4 v4, s[28:31], s52 offen lds
s_add_u32 s63, s63, 1
s_cmp_eq_u32 s63, 7
s_cselect_b32 s63, 0, s63
s_lshl_b32 s101, s63, 7
s_add_u32 s101, s101, s65
s_add_u32 m0, s67, 49152
s_nop 0
buffer_load_dwordx4 v3, s[24:27], s101 offen lds
s_add_u32 m0, s67, 57344
s_add_u32 s52, s101, 57344
buffer_load_dwordx4 v3, s[24:27], s52 offen lds
s_mul_i32 s5, s63, 172032
s_add_u32 s5, s5, s100
s_add_u32 m0, s67, 139264
s_add_u32 s52, s5, 896
buffer_load_dwordx4 v4, s[28:31], s52 offen lds
ds_read_b128 v[116:119], v6 offset:0
ds_read_b64_tr_b16 v[52:53], v10 offset:51200
ds_read_b64_tr_b16 v[54:55], v10 offset:51712
ds_read_b128 v[120:123], v7 offset:0
ds_read_b64_tr_b16 v[56:57], v10 offset:53248
ds_read_b64_tr_b16 v[58:59], v10 offset:53760
ds_read_b128 v[124:127], v8 offset:0
ds_read_b64_tr_b16 v[60:61], v10 offset:55296
ds_read_b64_tr_b16 v[62:63], v10 offset:55808
s_waitcnt vmcnt(6)
s_barrier
ds_read_b128 v[128:131], v5 offset:16384
ds_read_b64_tr_b16 v[64:65], v10 offset:57344
ds_read_b64_tr_b16 v[66:67], v10 offset:57856
s_waitcnt lgkmcnt(9)
v_mfma_f32_32x32x16_bf16 v[16:31], v[112:115], v[48:51], 0
s_add_u32 s63, s63, 1
s_cmp_eq_u32 s63, 7
s_cselect_b32 s63, 0, s63
s_lshl_b32 s101, s63, 7
s_add_u32 s101, s101, s65
s_add_u32 m0, s67, 65536
s_nop 0
buffer_load_dwordx4 v3, s[24:27], s101 offen lds
s_add_u32 m0, s67, 73728
s_add_u32 s52, s101, 57344
buffer_load_dwordx4 v3, s[24:27], s52 offen lds
s_mul_i32 s7, s63, 172032
s_add_u32 s7, s7, s100
s_add_u32 m0, s67, 147456
s_add_u32 s52, s7, 896
buffer_load_dwordx4 v4, s[28:31], s52 offen lds
ds_read_b128 v[132:135], v6 offset:16384
ds_read_b64_tr_b16 v[68:69], v10 offset:59392
ds_read_b64_tr_b16 v[70:71], v10 offset:59904
v_mfma_f32_32x32x16_bf16 v[16:31], v[116:119], v[52:55], v[16:31]
v_and_b32 v241, 31, v1
v_lshrrev_b32 v242, 5, v1
v_lshlrev_b32 v242, 2, v242
v_sub_u32 v241, v241, v242
s_mov_b32 s74, 0x3f80
v_and_b32 v242, 1, v241
v_lshlrev_b32 v242, 4, v242
v_lshlrev_b32 v242, v242, s74
v_lshrrev_b32 v241, 1, v241
v_cmp_eq_u32 vcc, 0, v241
s_nop 1
v_cndmask_b32 v104, 0, v242, vcc
v_cmp_eq_u32 vcc, 1, v241
s_nop 1
v_cndmask_b32 v105, 0, v242, vcc
ds_read_b128 v[136:139], v7 offset:16384
ds_read_b64_tr_b16 v[72:73], v10 offset:61440
ds_read_b64_tr_b16 v[74:75], v10 offset:61952
s_waitcnt lgkmcnt(9)
v_mfma_f32_32x32x16_bf16 v[16:31], v[120:123], v[56:59], v[16:31]
v_cmp_eq_u32 vcc, 4, v241
s_nop 1
v_cndmask_b32 v106, 0, v242, vcc
v_cmp_eq_u32 vcc, 5, v241
s_nop 1
v_cndmask_b32 v107, 0, v242, vcc
ds_read_b128 v[140:143], v8 offset:16384
ds_read_b64_tr_b16 v[76:77], v10 offset:63488
ds_read_b64_tr_b16 v[78:79], v10 offset:64000
v_mfma_f32_32x32x16_bf16 v[16:31], v[124:127], v[60:63], v[16:31]
s_lshr_b32 s53, s2, 4
s_lshl_b32 s53, s53, 3
s_and_b32 s54, s2, 7
s_add_u32 s53, s53, s54
s_mul_i32 s53, s53, 49
v_min_u32 v241, 48, v1
v_add_u32 v241, s53, v241
s_mov_b32 s53, 306783379
v_mul_hi_u32 v242, s53, v241
v_mul_u32_u24 v243, 14, v242
v_sub_u32 v241, v241, v243
s_cmp_ge_u32 s56, 3
s_cselect_b32 s54, 1879048192, 0
s_cmp_eq_u32 s56, 0
s_cbranch_scc0 Lpf1_12
v_add_u32 v243, 1, v241
v_lshrrev_b32 v243, 3, v243
v_mul_u32_u24 v243, 7, v243
v_add_u32 v241, v241, v243
v_mul_u32_u24 v242, 2688, v242
v_lshl_add_u32 v241, v241, 7, v242
buffer_load_dword v0, v241, s[28:31], 0 offen
s_branch Lpfd_14
Lpf1_12:
v_mad_u32_u24 v241, v242, 14, v241
v_lshlrev_b32 v241, 6, v241
s_cmp_eq_u32 s56, 1
s_cbranch_scc0 Lpf2_13
buffer_load_dword v0, v241, s[40:43], s54 offen
s_branch Lpfd_14
Lpf2_13:
buffer_load_dword v0, v241, s[44:47], s54 offen
Lpfd_14:
s_waitcnt vmcnt(7)
s_barrier
ds_read_b128 v[144:147], v5 offset:32768
ds_read_b64_tr_b16 v[48:49], v11 offset:0
ds_read_b64_tr_b16 v[50:51], v11 offset:512
s_waitcnt lgkmcnt(9)
v_mfma_f32_32x32x16_bf16 v[16:31], v[128:131], v[64:67], v[16:31]
s_add_u32 s63, s63, 1
s_cmp_eq_u32 s63, 7
s_cselect_b32 s63, 0, s63
s_lshl_b32 s101, s63, 7
s_add_u32 s101, s101, s65
s_add_u32 m0, s67, 81920
s_nop 0
buffer_load_dwordx4 v3, s[24:27], s101 offen lds
s_add_u32 m0, s67, 90112
s_add_u32 s52, s101, 57344
buffer_load_dwordx4 v3, s[24:27], s52 offen lds
s_mul_i32 s11, s63, 172032
s_add_u32 s11, s11, s100
s_add_u32 m0, s67, 155648
s_add_u32 s52, s11, 896
buffer_load_dwordx4 v4, s[28:31], s52 offen lds
ds_read_b128 v[148:151], v6 offset:32768
ds_read_b64_tr_b16 v[52:53], v11 offset:2048
ds_read_b64_tr_b16 v[54:55], v11 offset:2560
v_mfma_f32_32x32x16_bf16 v[16:31], v[132:135], v[68:71], v[16:31]
ds_read_b128 v[152:155], v7 offset:32768
ds_read_b64_tr_b16 v[56:57], v11 offset:4096
ds_read_b64_tr_b16 v[58:59], v11 offset:4608
s_waitcnt lgkmcnt(9)
v_mfma_f32_32x32x16_bf16 v[16:31], v[136:139], v[72:75], v[16:31]
s_mov_b32 s70, 0x3fb8aa3b
s_mov_b32 s72, 0x358637bd
s_mov_b32 s76, 0x3f803f80
s_mov_b32 s71, 0x3fb8aa3b
s_mov_b32 s73, 0x358637bd
s_mov_b32 s77, 0x3f803f80
s_mov_b32 s60, 0
s_mov_b32 s61, -1
s_lshl_b32 s53, s62, 4
s_add_u32 s53, s53, s59
s_lshl_b32 s53, s53, 11
s_lshl_b32 s54, s57, 9
s_add_u32 s53, s53, s54
s_add_u32 s4, s53, 8388608
ds_read_b128 v[156:159], v8 offset:32768
ds_read_b64_tr_b16 v[60:61], v11 offset:6144
ds_read_b64_tr_b16 v[62:63], v11 offset:6656
v_mfma_f32_32x32x16_bf16 v[16:31], v[140:143], v[76:79], v[16:31]
s_lshl_b32 s53, s62, 5
s_lshl_b32 s54, s57, 3
s_add_u32 s53, s53, s54
s_add_u32 s53, s53, s59
s_mul_i32 s53, s53, 128
s_add_u32 s12, s53, 9961472
s_bitcmp1_b32 s57, 0
s_cselect_b32 s4, 1879048192, s4
s_cselect_b32 s12, 1879048192, s12
s_and_b32 s54, s57, 1
s_lshr_b32 s55, s57, 1
s_lshl_b32 s53, s62, 1
s_add_u32 s53, s53, s54
s_lshl_b32 s53, s53, 1
s_add_u32 s53, s53, s55
s_waitcnt vmcnt(7)
s_barrier
ds_read_b128 v[160:163], v5 offset:49152
ds_read_b64_tr_b16 v[64:65], v11 offset:8192
ds_read_b64_tr_b16 v[66:67], v11 offset:8704
s_waitcnt lgkmcnt(9)
v_mfma_f32_32x32x16_bf16 v[16:31], v[144:147], v[48:51], v[16:31]
s_add_u32 s63, s63, 1
s_cmp_eq_u32 s63, 7
s_cselect_b32 s63, 0, s63
s_lshl_b32 s101, s63, 7
s_add_u32 s101, s101, s65
s_add_u32 m0, s67, 98304
s_nop 0
buffer_load_dwordx4 v3, s[24:27], s101 offen lds
s_add_u32 m0, s67, 106496
s_add_u32 s52, s101, 57344
buffer_load_dwordx4 v3, s[24:27], s52 offen lds
s_mul_i32 s13, s63, 172032
s_add_u32 s13, s13, s100
s_add_u32 m0, s67, 114688
s_add_u32 s52, s13, 896
buffer_load_dwordx4 v4, s[28:31], s52 offen lds
ds_read_b128 v[164:167], v6 offset:49152
ds_read_b64_tr_b16 v[68:69], v11 offset:10240
ds_read_b64_tr_b16 v[70:71], v11 offset:10752
v_mfma_f32_32x32x16_bf16 v[16:31], v[148:151], v[52:55], v[16:31]
s_mul_i32 s53, s53, 1024
s_add_u32 s6, s53, 9961472
s_lshl_b32 s53, s62, 15
s_lshl_b32 s55, s55, 14
s_add_u32 s53, s53, s55
s_lshl_b32 s54, s54, 10
s_add_u32 s53, s53, s54
s_add_u32 s14, s53, 8388608
s_and_b32 s54, s59, 1
s_lshl_b32 s54, s54, 13
s_add_u32 s14, s14, s54
v_and_b32 v248, 7, v1
v_mul_u32_u24 v248, 128, v248
ds_read_b128 v[168:171], v7 offset:49152
ds_read_b64_tr_b16 v[72:73], v11 offset:12288
ds_read_b64_tr_b16 v[74:75], v11 offset:12800
s_waitcnt lgkmcnt(9)
v_mfma_f32_32x32x16_bf16 v[16:31], v[152:155], v[56:59], v[16:31]
s_lshl_b32 s53, s56, 12
s_add_u32 s53, s53, 8192
v_add_u32 v245, s53, v2
s_lshl_b32 s53, s58, 14
s_lshl_b32 s54, s57, 10
s_add_u32 s53, s53, s54
s_add_u32 s53, s53, 8192
v_add_u32 v250, s53, v2
s_lshl_b32 s53, s58, 12
s_add_u32 s53, s53, 57344
v_add_u32 v253, s53, v2
s_lshl_b32 s54, s57, 10
v_add_u32 v252, s54, v253
ds_read_b128 v[172:175], v8 offset:49152
ds_read_b64_tr_b16 v[76:77], v11 offset:14336
ds_read_b64_tr_b16 v[78:79], v11 offset:14848
v_mfma_f32_32x32x16_bf16 v[16:31], v[156:159], v[60:63], v[16:31]
v_mov_b32 v247, 0
global_load_dword v246, v247, s[20:21] sc1
s_waitcnt vmcnt(8)
s_barrier
v_add_u32 v5, 0x10000, v5
v_add_u32 v6, 0x10000, v6
v_add_u32 v7, 0x10000, v7
v_add_u32 v8, 0x10000, v8
ds_read_b128 v[176:179], v5 offset:0
ds_read_b64_tr_b16 v[48:49], v11 offset:16384
ds_read_b64_tr_b16 v[50:51], v11 offset:16896
s_waitcnt lgkmcnt(9)
v_mfma_f32_32x32x16_bf16 v[16:31], v[160:163], v[64:67], v[16:31]
s_add_u32 m0, s67, 8192
s_add_u32 s52, s0, 1792
buffer_load_dwordx4 v4, s[28:31], s52 offen lds
ds_read_b128 v[180:183], v6 offset:0
ds_read_b64_tr_b16 v[52:53], v11 offset:18432
ds_read_b64_tr_b16 v[54:55], v11 offset:18944
v_mfma_f32_32x32x16_bf16 v[16:31], v[164:167], v[68:71], v[16:31]
ds_read_b128 v[184:187], v7 offset:0
ds_read_b64_tr_b16 v[56:57], v11 offset:20480
ds_read_b64_tr_b16 v[58:59], v11 offset:20992
s_waitcnt lgkmcnt(9)
v_mfma_f32_32x32x16_bf16 v[16:31], v[168:171], v[72:75], v[16:31]
ds_read_b128 v[188:191], v8 offset:0
ds_read_b64_tr_b16 v[60:61], v11 offset:22528
ds_read_b64_tr_b16 v[62:63], v11 offset:23040
v_mfma_f32_32x32x16_bf16 v[16:31], v[172:175], v[76:79], v[16:31]
s_waitcnt vmcnt(5)
s_barrier
ds_read_b128 v[192:195], v5 offset:16384
ds_read_b64_tr_b16 v[64:65], v11 offset:24576
ds_read_b64_tr_b16 v[66:67], v11 offset:25088
s_waitcnt lgkmcnt(9)
v_mfma_f32_32x32x16_bf16 v[16:31], v[176:179], v[48:51], v[16:31]
s_add_u32 m0, s67, 16384
s_add_u32 s52, s1, 1792
buffer_load_dwordx4 v4, s[28:31], s52 offen lds
s_add_u32 m0, s67, 32768
s_add_u32 s52, s66, 1792
buffer_load_dwordx4 v4, s[28:31], s52 offen lds
ds_read_b128 v[196:199], v6 offset:16384
ds_read_b64_tr_b16 v[68:69], v11 offset:26624
ds_read_b64_tr_b16 v[70:71], v11 offset:27136
v_mfma_f32_32x32x16_bf16 v[16:31], v[180:183], v[52:55], v[16:31]
s_mov_b32 s26, s10
s_mov_b32 s27, s15
v_lshrrev_b32 v244, 3, v1
v_mul_u32_u24 v3, 896, v244
v_and_b32 v244, 2, v244
v_lshlrev_b32 v244, 1, v244
v_and_b32 v241, 7, v1
v_xor_b32 v244, v244, v241
v_lshl_add_u32 v3, v244, 4, v3
ds_read_b128 v[200:203], v7 offset:16384
ds_read_b64_tr_b16 v[72:73], v11 offset:28672
ds_read_b64_tr_b16 v[74:75], v11 offset:29184
s_waitcnt lgkmcnt(9)
v_mfma_f32_32x32x16_bf16 v[16:31], v[184:187], v[56:59], v[16:31]
ds_read_b128 v[204:207], v8 offset:16384
ds_read_b64_tr_b16 v[76:77], v11 offset:30720
ds_read_b64_tr_b16 v[78:79], v11 offset:31232
v_mfma_f32_32x32x16_bf16 v[16:31], v[188:191], v[60:63], v[16:31]
s_waitcnt vmcnt(4)
s_barrier
ds_read_b128 v[208:211], v5 offset:32768
ds_read_b64_tr_b16 v[48:49], v10 offset:49152
ds_read_b64_tr_b16 v[50:51], v10 offset:49664
s_waitcnt lgkmcnt(9)
v_mfma_f32_32x32x16_bf16 v[16:31], v[192:195], v[64:67], v[16:31]
s_add_u32 m0, s67, 40960
s_add_u32 s52, s5, 1792
buffer_load_dwordx4 v4, s[28:31], s52 offen lds
ds_read_b128 v[212:215], v6 offset:32768
ds_read_b64_tr_b16 v[52:53], v10 offset:51200
ds_read_b64_tr_b16 v[54:55], v10 offset:51712
v_mfma_f32_32x32x16_bf16 v[16:31], v[196:199], v[68:71], v[16:31]
ds_read_b128 v[216:219], v7 offset:32768
ds_read_b64_tr_b16 v[56:57], v10 offset:53248
ds_read_b64_tr_b16 v[58:59], v10 offset:53760
s_waitcnt lgkmcnt(9)
v_mfma_f32_32x32x16_bf16 v[16:31], v[200:203], v[72:75], v[16:31]
ds_read_b128 v[220:223], v8 offset:32768
ds_read_b64_tr_b16 v[60:61], v10 offset:55296
ds_read_b64_tr_b16 v[62:63], v10 offset:55808
v_mfma_f32_32x32x16_bf16 v[16:31], v[204:207], v[76:79], v[16:31]
s_waitcnt vmcnt(4)
v_cmp_eq_u32 vcc, 0, v246
s_cbranch_vccnz Lnon_15
Lnonb_16:
v_readfirstlane_b32 s63, v246
v_and_b32 v5, 3, v1
v_lshlrev_b32 v5, 3, v5
v_lshrrev_b32 v5, v5, v246
v_and_b32 v5, 0x9f7f, v5
v_or_b32 v5, 0x80, v5
v_lshlrev_b32 v5, 16, v5
s_add_u32 s53, s36, -131072
s_add_u32 s20, s22, s53
s_addc_u32 s21, s23, 0
s_add_u32 s24, s22, s36
s_addc_u32 s25, s23, 0
s_waitcnt vmcnt(2)
s_barrier
ds_read_b64_tr_b16 v[64:65], v9 offset:8192
ds_read_b64_tr_b16 v[66:67], v9 offset:8704
s_waitcnt lgkmcnt(8)
v_mfma_f32_32x32x16_bf16 v[16:31], v[208:211], v[48:51], v[16:31]
s_add_u32 m0, s67, 139264
s_add_u32 s52, s7, 1792
buffer_load_dwordx4 v4, s[28:31], s52 offen lds
ds_read_b64_tr_b16 v[68:69], v9 offset:10240
ds_read_b64_tr_b16 v[70:71], v9 offset:10752
v_mfma_f32_32x32x16_bf16 v[16:31], v[212:215], v[52:55], v[16:31]
ds_read_b64_tr_b16 v[72:73], v9 offset:12288
ds_read_b64_tr_b16 v[74:75], v9 offset:12800
s_waitcnt lgkmcnt(6)
v_mfma_f32_32x32x16_bf16 v[16:31], v[216:219], v[56:59], v[16:31]
ds_read_b64_tr_b16 v[76:77], v9 offset:14336
ds_read_b64_tr_b16 v[78:79], v9 offset:14848
v_mfma_f32_32x32x16_bf16 v[16:31], v[220:223], v[60:63], v[16:31]
ds_read_b64_tr_b16 v[48:49], v9 offset:16384
ds_read_b64_tr_b16 v[50:51], v9 offset:16896
s_waitcnt lgkmcnt(6)
v_mfma_f32_32x32x16_bf16 v[32:47], v[112:115], v[64:67], 0
s_add_u32 m0, s67, 147456
s_add_u32 s52, s11, 1792
buffer_load_dwordx4 v4, s[28:31], s52 offen lds
ds_read_b64_tr_b16 v[52:53], v9 offset:18432
ds_read_b64_tr_b16 v[54:55], v9 offset:18944
v_mfma_f32_32x32x16_bf16 v[32:47], v[116:119], v[68:71], v[32:47]
s_nop 1
v_pk_mul_f32 v[96:97], v[16:17], s[70:71]
v_pk_mul_f32 v[98:99], v[18:19], s[70:71]
v_pk_mul_f32 v[100:101], v[20:21], s[70:71]
v_pk_mul_f32 v[102:103], v[22:23], s[70:71]
v_exp_f32 v96, v96
v_exp_f32 v97, v97
v_exp_f32 v98, v98
v_exp_f32 v99, v99
ds_read_b64_tr_b16 v[56:57], v9 offset:20480
ds_read_b64_tr_b16 v[58:59], v9 offset:20992
s_waitcnt lgkmcnt(6)
v_mfma_f32_32x32x16_bf16 v[32:47], v[120:123], v[72:75], v[32:47]
v_exp_f32 v100, v100
v_exp_f32 v101, v101
v_exp_f32 v102, v102
v_exp_f32 v103, v103
v_pk_add_f32 v[16:17], v[16:17], 1.0 op_sel_hi:[1,0]
v_pk_add_f32 v[18:19], v[18:19], 1.0 op_sel_hi:[1,0]
v_pk_add_f32 v[20:21], v[20:21], 1.0 op_sel_hi:[1,0]
v_pk_add_f32 v[22:23], v[22:23], 1.0 op_sel_hi:[1,0]
ds_read_b64_tr_b16 v[60:61], v9 offset:22528
ds_read_b64_tr_b16 v[62:63], v9 offset:23040
v_mfma_f32_32x32x16_bf16 v[32:47], v[124:127], v[76:79], v[32:47]
v_med3_f32 v16, v96, v16, 1.0
v_med3_f32 v17, v97, v17, 1.0
v_med3_f32 v18, v98, v18, 1.0
v_med3_f32 v19, v99, v19, 1.0
v_med3_f32 v20, v100, v20, 1.0
v_med3_f32 v21, v101, v21, 1.0
v_med3_f32 v22, v102, v22, 1.0
v_med3_f32 v23, v103, v23, 1.0
s_waitcnt vmcnt(2)
s_barrier
ds_read_b64_tr_b16 v[64:65], v9 offset:32768
ds_read_b64_tr_b16 v[66:67], v9 offset:33280
s_waitcnt lgkmcnt(6)
v_mfma_f32_32x32x16_bf16 v[32:47], v[128:131], v[48:51], v[32:47]
s_add_u32 m0, s67, 155648
s_add_u32 s52, s13, 1792
buffer_load_dwordx4 v4, s[28:31], s52 offen lds
ds_read_b64_tr_b16 v[68:69], v9 offset:34816
ds_read_b64_tr_b16 v[70:71], v9 offset:35328
v_mfma_f32_32x32x16_bf16 v[32:47], v[132:135], v[52:55], v[32:47]
v_pk_add_f32 v[16:17], v[16:17], s[72:73]
v_pk_add_f32 v[18:19], v[18:19], s[72:73]
v_pk_add_f32 v[20:21], v[20:21], s[72:73]
v_pk_add_f32 v[22:23], v[22:23], s[72:73]
v_pk_mul_f32 v[96:97], v[24:25], s[70:71]
v_pk_mul_f32 v[98:99], v[26:27], s[70:71]
v_pk_mul_f32 v[100:101], v[28:29], s[70:71]
v_pk_mul_f32 v[102:103], v[30:31], s[70:71]
ds_read_b64_tr_b16 v[72:73], v9 offset:36864
ds_read_b64_tr_b16 v[74:75], v9 offset:37376
s_waitcnt lgkmcnt(6)
v_mfma_f32_32x32x16_bf16 v[32:47], v[136:139], v[56:59], v[32:47]
v_exp_f32 v96, v96
v_exp_f32 v97, v97
v_exp_f32 v98, v98
v_exp_f32 v99, v99
v_exp_f32 v100, v100
v_exp_f32 v101, v101
v_exp_f32 v102, v102
v_exp_f32 v103, v103
ds_read_b64_tr_b16 v[76:77], v9 offset:38912
ds_read_b64_tr_b16 v[78:79], v9 offset:39424
v_mfma_f32_32x32x16_bf16 v[32:47], v[140:143], v[60:63], v[32:47]
v_pk_add_f32 v[24:25], v[24:25], 1.0 op_sel_hi:[1,0]
v_pk_add_f32 v[26:27], v[26:27], 1.0 op_sel_hi:[1,0]
v_pk_add_f32 v[28:29], v[28:29], 1.0 op_sel_hi:[1,0]
v_pk_add_f32 v[30:31], v[30:31], 1.0 op_sel_hi:[1,0]
v_med3_f32 v24, v96, v24, 1.0
v_med3_f32 v25, v97, v25, 1.0
v_med3_f32 v26, v98, v26, 1.0
v_med3_f32 v27, v99, v27, 1.0
ds_read_b64_tr_b16 v[48:49], v9 offset:40960
ds_read_b64_tr_b16 v[50:51], v9 offset:41472
s_waitcnt lgkmcnt(6)
v_mfma_f32_32x32x16_bf16 v[32:47], v[144:147], v[64:67], v[32:47]
s_mov_b64 exec, s[38:39]
s_add_u32 m0, s67, 57344
s_nop 0
buffer_load_dwordx4 v4, s[28:31], s0 offen lds
s_mov_b64 exec, -1
ds_read_b64_tr_b16 v[52:53], v9 offset:43008
ds_read_b64_tr_b16 v[54:55], v9 offset:43520
v_mfma_f32_32x32x16_bf16 v[32:47], v[148:151], v[68:71], v[32:47]
v_med3_f32 v28, v100, v28, 1.0
v_med3_f32 v29, v101, v29, 1.0
v_med3_f32 v30, v102, v30, 1.0
v_med3_f32 v31, v103, v31, 1.0
v_pk_add_f32 v[24:25], v[24:25], s[72:73]
v_pk_add_f32 v[26:27], v[26:27], s[72:73]
v_pk_add_f32 v[28:29], v[28:29], s[72:73]
v_pk_add_f32 v[30:31], v[30:31], s[72:73]
ds_read_b64_tr_b16 v[56:57], v9 offset:45056
ds_read_b64_tr_b16 v[58:59], v9 offset:45568
s_waitcnt lgkmcnt(6)
v_mfma_f32_32x32x16_bf16 v[32:47], v[152:155], v[72:75], v[32:47]
v_cvt_pk_bf16_f32 v80, v16, v17
v_cvt_pk_bf16_f32 v81, v18, v19
v_cvt_pk_bf16_f32 v82, v20, v21
v_cvt_pk_bf16_f32 v83, v22, v23
v_cvt_pk_bf16_f32 v84, v24, v25
v_cvt_pk_bf16_f32 v85, v26, v27
v_cvt_pk_bf16_f32 v86, v28, v29
v_cvt_pk_bf16_f32 v87, v30, v31
ds_read_b64_tr_b16 v[60:61], v9 offset:47104
ds_read_b64_tr_b16 v[62:63], v9 offset:47616
v_mfma_f32_32x32x16_bf16 v[32:47], v[156:159], v[76:79], v[32:47]
s_mov_b32 exec_hi, 0xffffff
ds_write_b64 v14, v[12:13]
s_mov_b32 exec_hi, -1
s_waitcnt vmcnt(2)
s_waitcnt lgkmcnt(0)
s_barrier
ds_read_b64_tr_b16 v[64:65], v11 offset:8192
ds_read_b64_tr_b16 v[66:67], v11 offset:8704
v_mfma_f32_32x32x16_bf16 v[32:47], v[160:163], v[48:51], v[32:47]
s_mov_b64 exec, s[38:39]
s_add_u32 m0, s67, 65536
s_nop 0
buffer_load_dwordx4 v4, s[28:31], s1 offen lds
s_mov_b64 exec, -1
ds_read_b64_tr_b16 v[68:69], v11 offset:10240
ds_read_b64_tr_b16 v[70:71], v11 offset:10752
v_mfma_f32_32x32x16_bf16 v[32:47], v[164:167], v[52:55], v[32:47]
ds_read_b64_tr_b16 v[72:73], v11 offset:12288
ds_read_b64_tr_b16 v[74:75], v11 offset:12800
v_mfma_f32_32x32x16_bf16 v[32:47], v[168:171], v[56:59], v[32:47]
ds_read_b64_tr_b16 v[76:77], v11 offset:14336
ds_read_b64_tr_b16 v[78:79], v11 offset:14848
v_mfma_f32_32x32x16_bf16 v[32:47], v[172:175], v[60:63], v[32:47]
ds_read_b64_tr_b16 v[48:49], v11 offset:16384
ds_read_b64_tr_b16 v[50:51], v11 offset:16896
s_waitcnt lgkmcnt(6)
v_mfma_f32_32x32x16_bf16 v[32:47], v[176:179], v[64:67], v[32:47]
s_mov_b64 exec, s[38:39]
s_add_u32 m0, s67, 81920
s_nop 0
buffer_load_dwordx4 v4, s[28:31], s66 offen lds
s_mov_b64 exec, -1
s_mov_b64 exec, s[38:39]
s_add_u32 m0, s67, 90112
s_nop 0
buffer_load_dwordx4 v4, s[28:31], s5 offen lds
s_mov_b64 exec, -1
ds_read_b64_tr_b16 v[52:53], v11 offset:18432
ds_read_b64_tr_b16 v[54:55], v11 offset:18944
v_mfma_f32_32x32x16_bf16 v[32:47], v[180:183], v[68:71], v[32:47]
ds_read_b64_tr_b16 v[56:57], v11 offset:20480
ds_read_b64_tr_b16 v[58:59], v11 offset:20992
s_waitcnt lgkmcnt(6)
v_mfma_f32_32x32x16_bf16 v[32:47], v[184:187], v[72:75], v[32:47]
ds_read_b64_tr_b16 v[60:61], v11 offset:22528
ds_read_b64_tr_b16 v[62:63], v11 offset:23040
v_mfma_f32_32x32x16_bf16 v[32:47], v[188:191], v[76:79], v[32:47]
s_waitcnt vmcnt(4)
s_barrier
ds_read_b64_tr_b16 v[64:65], v11 offset:24576
ds_read_b64_tr_b16 v[66:67], v11 offset:25088
s_waitcnt lgkmcnt(6)
v_mfma_f32_32x32x16_bf16 v[32:47], v[192:195], v[48:51], v[32:47]
s_mov_b64 exec, s[38:39]
s_add_u32 m0, s67, 106496
s_nop 0
buffer_load_dwordx4 v4, s[28:31], s7 offen lds
s_mov_b64 exec, -1
ds_read_b64_tr_b16 v[68:69], v11 offset:26624
ds_read_b64_tr_b16 v[70:71], v11 offset:27136
v_mfma_f32_32x32x16_bf16 v[32:47], v[196:199], v[52:55], v[32:47]
ds_read_b64_tr_b16 v[72:73], v11 offset:28672
ds_read_b64_tr_b16 v[74:75], v11 offset:29184
s_waitcnt lgkmcnt(6)
v_mfma_f32_32x32x16_bf16 v[32:47], v[200:203], v[56:59], v[32:47]
ds_read_b64_tr_b16 v[76:77], v11 offset:30720
ds_read_b64_tr_b16 v[78:79], v11 offset:31232
v_mfma_f32_32x32x16_bf16 v[32:47], v[204:207], v[60:63], v[32:47]
s_waitcnt vmcnt(4)
s_barrier
s_waitcnt lgkmcnt(4)
v_mfma_f32_32x32x16_bf16 v[32:47], v[208:211], v[64:67], v[32:47]
v_mfma_f32_32x32x16_bf16 v[32:47], v[212:215], v[68:71], v[32:47]
s_waitcnt lgkmcnt(0)
v_mfma_f32_32x32x16_bf16 v[32:47], v[216:219], v[72:75], v[32:47]
v_mfma_f32_32x32x16_bf16 v[32:47], v[220:223], v[76:79], v[32:47]
s_nop 11
v_cvt_pk_bf16_f32 v88, v32, v33
v_cvt_pk_bf16_f32 v89, v34, v35
v_cvt_pk_bf16_f32 v90, v36, v37
v_cvt_pk_bf16_f32 v91, v38, v39
v_cvt_pk_bf16_f32 v92, v40, v41
v_cvt_pk_bf16_f32 v93, v42, v43
v_cvt_pk_bf16_f32 v94, v44, v45
v_cvt_pk_bf16_f32 v95, v46, v47
s_mov_b32 exec_lo, 0x10000000
s_mov_b32 exec_hi, 0x10000000
v_pk_mov_b32 v[88:89], s[76:77], s[76:77] op_sel:[0,1]
v_pk_mov_b32 v[90:91], s[76:77], s[76:77] op_sel:[0,1]
v_pk_mov_b32 v[92:93], s[76:77], s[76:77] op_sel:[0,1]
v_pk_mov_b32 v[94:95], s[76:77], s[76:77] op_sel:[0,1]
s_mov_b64 exec, -1
v_mfma_f32_32x32x16_bf16 v[16:31], v[80:83], v[88:91], 0
v_mfma_f32_32x32x16_bf16 v[16:31], v[84:87], v[92:95], v[16:31]
ds_read_b64_tr_b16 v[48:49], v9 offset:57344
ds_read_b64_tr_b16 v[50:51], v9 offset:57856
ds_read_b64_tr_b16 v[52:53], v9 offset:59392
ds_read_b64_tr_b16 v[54:55], v9 offset:59904
ds_read_b64_tr_b16 v[56:57], v9 offset:61440
ds_read_b64_tr_b16 v[58:59], v9 offset:61952
ds_read_b64_tr_b16 v[60:61], v9 offset:63488
ds_read_b64_tr_b16 v[62:63], v9 offset:64000
s_mov_b64 exec, s[38:39]
s_add_u32 m0, s67, 114688
s_nop 0
buffer_load_dwordx4 v4, s[28:31], s11 offen lds
s_mov_b64 exec, -1
ds_write_b128 v245, v[16:19] offset:0
ds_write_b128 v245, v[20:23] offset:1024
ds_write_b128 v245, v[24:27] offset:2048
ds_write_b128 v245, v[28:31] offset:3072
s_waitcnt vmcnt(3)
s_waitcnt lgkmcnt(0)
s_barrier
s_bitcmp1_b32 s57, 0
s_cbranch_scc1 Lnored_17
ds_read_b128 v[16:19], v250 offset:0
ds_read_b128 v[20:23], v250 offset:1024
ds_read_b128 v[24:27], v250 offset:4096
ds_read_b128 v[28:31], v250 offset:5120
ds_read_b128 v[32:35], v250 offset:8192
ds_read_b128 v[36:39], v250 offset:9216
ds_read_b128 v[40:43], v250 offset:12288
ds_read_b128 v[44:47], v250 offset:13312
s_waitcnt lgkmcnt(0)
v_pk_add_f32 v[16:17], v[16:17], v[24:25]
v_pk_add_f32 v[32:33], v[32:33], v[40:41]
v_pk_add_f32 v[18:19], v[18:19], v[26:27]
v_pk_add_f32 v[34:35], v[34:35], v[42:43]
v_pk_add_f32 v[20:21], v[20:21], v[28:29]
v_pk_add_f32 v[36:37], v[36:37], v[44:45]
v_pk_add_f32 v[22:23], v[22:23], v[30:31]
v_pk_add_f32 v[38:39], v[38:39], v[46:47]
v_pk_add_f32 v[16:17], v[16:17], v[32:33]
v_pk_add_f32 v[18:19], v[18:19], v[34:35]
v_pk_add_f32 v[20:21], v[20:21], v[36:37]
v_pk_add_f32 v[22:23], v[22:23], v[38:39]
v_cvt_pk_bf16_f32 v24, v16, v17
v_cvt_pk_bf16_f32 v25, v18, v19
v_cvt_pk_bf16_f32 v26, v20, v21
v_cvt_pk_bf16_f32 v27, v22, v23
Lnored_17:
buffer_store_dwordx4 v[24:27], v2, s[32:35], s4 offen sc1
ds_read_b64_tr_b16 v[64:65], v10 offset:0
ds_read_b64_tr_b16 v[66:67], v10 offset:512
v_mfma_f32_32x32x16_bf16 v[224:239], v[48:51], v[112:115], 0
s_mov_b64 exec, s[38:39]
s_add_u32 m0, s67, 131072
s_nop 0
buffer_load_dwordx4 v4, s[28:31], s13 offen lds
s_mov_b64 exec, -1
ds_read_b64_tr_b16 v[68:69], v10 offset:2048
ds_read_b64_tr_b16 v[70:71], v10 offset:2560
v_mfma_f32_32x32x16_bf16 v[224:239], v[52:55], v[116:119], v[224:239]
ds_read_b64_tr_b16 v[72:73], v10 offset:4096
ds_read_b64_tr_b16 v[74:75], v10 offset:4608
v_mfma_f32_32x32x16_bf16 v[224:239], v[56:59], v[120:123], v[224:239]
ds_read_b64_tr_b16 v[76:77], v10 offset:6144
ds_read_b64_tr_b16 v[78:79], v10 offset:6656
v_mfma_f32_32x32x16_bf16 v[224:239], v[60:63], v[124:127], v[224:239]
s_waitcnt vmcnt(1)
buffer_store_dword v246, v254, s[32:35], s12 offen sc1
ds_read_b64_tr_b16 v[48:49], v10 offset:16384
ds_read_b64_tr_b16 v[50:51], v10 offset:16896
s_waitcnt lgkmcnt(6)
v_mfma_f32_32x32x16_bf16 v[224:239], v[64:67], v[128:131], v[224:239]
ds_read_b64_tr_b16 v[52:53], v10 offset:18432
ds_read_b64_tr_b16 v[54:55], v10 offset:18944
v_mfma_f32_32x32x16_bf16 v[224:239], v[68:71], v[132:135], v[224:239]
ds_read_b64_tr_b16 v[56:57], v10 offset:20480
ds_read_b64_tr_b16 v[58:59], v10 offset:20992
s_waitcnt lgkmcnt(6)
v_mfma_f32_32x32x16_bf16 v[224:239], v[72:75], v[136:139], v[224:239]
ds_read_b64_tr_b16 v[60:61], v10 offset:22528
ds_read_b64_tr_b16 v[62:63], v10 offset:23040
v_mfma_f32_32x32x16_bf16 v[224:239], v[76:79], v[140:143], v[224:239]
s_add_u32 m0, s67, 122880
s_add_u32 s52, s26, 114688
buffer_load_dwordx4 v3, s[40:43], s52 offen lds
s_add_u32 m0, s67, 139264
s_add_u32 s52, s26, 229376
buffer_load_dwordx4 v3, s[40:43], s52 offen lds
s_barrier
ds_read_b64_tr_b16 v[64:65], v10 offset:24576
ds_read_b64_tr_b16 v[66:67], v10 offset:25088
s_waitcnt lgkmcnt(6)
v_mfma_f32_32x32x16_bf16 v[224:239], v[48:51], v[144:147], v[224:239]
ds_read_b64_tr_b16 v[68:69], v10 offset:26624
ds_read_b64_tr_b16 v[70:71], v10 offset:27136
v_mfma_f32_32x32x16_bf16 v[224:239], v[52:55], v[148:151], v[224:239]
ds_read_b64_tr_b16 v[72:73], v10 offset:28672
ds_read_b64_tr_b16 v[74:75], v10 offset:29184
s_waitcnt lgkmcnt(6)
v_mfma_f32_32x32x16_bf16 v[224:239], v[56:59], v[152:155], v[224:239]
ds_read_b64_tr_b16 v[76:77], v10 offset:30720
ds_read_b64_tr_b16 v[78:79], v10 offset:31232
v_mfma_f32_32x32x16_bf16 v[224:239], v[60:63], v[156:159], v[224:239]
s_add_u32 m0, s67, 147456
s_add_u32 s52, s26, 286720
buffer_load_dwordx4 v3, s[40:43], s52 offen lds
s_add_u32 m0, s67, 155648
s_add_u32 s52, s26, 344064
buffer_load_dwordx4 v3, s[40:43], s52 offen lds
ds_read_b64_tr_b16 v[48:49], v10 offset:40960
ds_read_b64_tr_b16 v[50:51], v10 offset:41472
s_waitcnt lgkmcnt(6)
v_mfma_f32_32x32x16_bf16 v[224:239], v[64:67], v[160:163], v[224:239]
ds_read_b64_tr_b16 v[52:53], v10 offset:43008
ds_read_b64_tr_b16 v[54:55], v10 offset:43520
v_mfma_f32_32x32x16_bf16 v[224:239], v[68:71], v[164:167], v[224:239]
ds_read_b64_tr_b16 v[56:57], v10 offset:45056
ds_read_b64_tr_b16 v[58:59], v10 offset:45568
s_waitcnt lgkmcnt(6)
v_mfma_f32_32x32x16_bf16 v[224:239], v[72:75], v[168:171], v[224:239]
ds_read_b64_tr_b16 v[60:61], v10 offset:47104
ds_read_b64_tr_b16 v[62:63], v10 offset:47616
v_mfma_f32_32x32x16_bf16 v[224:239], v[76:79], v[172:175], v[224:239]
s_waitcnt vmcnt(5)
s_barrier
ds_read_b64_tr_b16 v[64:65], v10 offset:49152
ds_read_b64_tr_b16 v[66:67], v10 offset:49664
s_waitcnt lgkmcnt(6)
v_mfma_f32_32x32x16_bf16 v[224:239], v[48:51], v[176:179], v[224:239]
ds_read_b64_tr_b16 v[68:69], v10 offset:51200
ds_read_b64_tr_b16 v[70:71], v10 offset:51712
v_mfma_f32_32x32x16_bf16 v[224:239], v[52:55], v[180:183], v[224:239]
ds_read_b64_tr_b16 v[72:73], v10 offset:53248
ds_read_b64_tr_b16 v[74:75], v10 offset:53760
s_waitcnt lgkmcnt(6)
v_mfma_f32_32x32x16_bf16 v[224:239], v[56:59], v[184:187], v[224:239]
ds_read_b64_tr_b16 v[76:77], v10 offset:55296
ds_read_b64_tr_b16 v[78:79], v10 offset:55808
v_mfma_f32_32x32x16_bf16 v[224:239], v[60:63], v[188:191], v[224:239]
ds_read_b64_tr_b16 v[48:49], v11 offset:0
ds_read_b64_tr_b16 v[50:51], v11 offset:512
s_waitcnt lgkmcnt(6)
v_mfma_f32_32x32x16_bf16 v[224:239], v[64:67], v[192:195], v[224:239]
ds_read_b64_tr_b16 v[52:53], v11 offset:2048
ds_read_b64_tr_b16 v[54:55], v11 offset:2560
v_mfma_f32_32x32x16_bf16 v[224:239], v[68:71], v[196:199], v[224:239]
ds_read_b64_tr_b16 v[56:57], v11 offset:4096
ds_read_b64_tr_b16 v[58:59], v11 offset:4608
s_waitcnt lgkmcnt(6)
v_mfma_f32_32x32x16_bf16 v[224:239], v[72:75], v[200:203], v[224:239]
ds_read_b64_tr_b16 v[60:61], v11 offset:6144
ds_read_b64_tr_b16 v[62:63], v11 offset:6656
v_mfma_f32_32x32x16_bf16 v[224:239], v[76:79], v[204:207], v[224:239]
buffer_load_dword v249, v248, s[32:35], s6 offen sc1
s_waitcnt lgkmcnt(4)
v_mfma_f32_32x32x16_bf16 v[224:239], v[48:51], v[208:211], v[224:239]
v_mfma_f32_32x32x16_bf16 v[224:239], v[52:55], v[212:215], v[224:239]
s_waitcnt lgkmcnt(0)
v_mfma_f32_32x32x16_bf16 v[224:239], v[56:59], v[216:219], v[224:239]
v_mfma_f32_32x32x16_bf16 v[224:239], v[60:63], v[220:223], v[224:239]
s_barrier
s_waitcnt vmcnt(0)
v_cmp_ne_u32 vcc, v246, v249
s_cbranch_vccnz Lvp_18
Lvpb_19:
buffer_load_dwordx4 v[112:115], v2, s[32:35], s14 offen offset:0 sc1
buffer_load_dwordx4 v[116:119], v2, s[32:35], s14 offen offset:2048 sc1
s_xor_b32 s14, s14, 4096
buffer_load_dwordx4 v[120:123], v2, s[32:35], s14 offen offset:0 sc1
buffer_load_dwordx4 v[124:127], v2, s[32:35], s14 offen offset:2048 sc1
s_xor_b32 s14, s14, 12288
buffer_load_dwordx4 v[128:131], v2, s[32:35], s14 offen offset:0 sc1
buffer_load_dwordx4 v[132:135], v2, s[32:35], s14 offen offset:2048 sc1
s_xor_b32 s14, s14, 4096
buffer_load_dwordx4 v[136:139], v2, s[32:35], s14 offen offset:0 sc1
buffer_load_dwordx4 v[140:143], v2, s[32:35], s14 offen offset:2048 sc1
v_mul_f32 v240, s70, v236
v_exp_f32 v240, v240
v_pk_mul_f32 v[48:49], v[224:225], s[70:71]
v_pk_mul_f32 v[50:51], v[226:227], s[70:71]
v_pk_mul_f32 v[52:53], v[228:229], s[70:71]
v_pk_mul_f32 v[54:55], v[230:231], s[70:71]
v_exp_f32 v48, v48
v_exp_f32 v49, v49
v_exp_f32 v50, v50
v_exp_f32 v51, v51
v_exp_f32 v52, v52
v_exp_f32 v53, v53
v_exp_f32 v54, v54
v_exp_f32 v55, v55
v_pk_add_f32 v[224:225], v[224:225], 1.0 op_sel_hi:[1,0]
v_pk_add_f32 v[226:227], v[226:227], 1.0 op_sel_hi:[1,0]
v_pk_add_f32 v[228:229], v[228:229], 1.0 op_sel_hi:[1,0]
v_pk_add_f32 v[230:231], v[230:231], 1.0 op_sel_hi:[1,0]
v_med3_f32 v224, v48, v224, 1.0
v_med3_f32 v225, v49, v225, 1.0
v_med3_f32 v226, v50, v226, 1.0
v_med3_f32 v227, v51, v227, 1.0
v_med3_f32 v228, v52, v228, 1.0
v_med3_f32 v229, v53, v229, 1.0
v_med3_f32 v230, v54, v230, 1.0
v_med3_f32 v231, v55, v231, 1.0
v_pk_add_f32 v[224:225], v[224:225], s[72:73]
v_pk_add_f32 v[226:227], v[226:227], s[72:73]
v_pk_add_f32 v[228:229], v[228:229], s[72:73]
v_pk_add_f32 v[230:231], v[230:231], s[72:73]
v_pk_mul_f32 v[48:49], v[232:233], s[70:71]
v_pk_mul_f32 v[50:51], v[234:235], s[70:71]
v_pk_mul_f32 v[52:53], v[236:237], s[70:71]
v_pk_mul_f32 v[54:55], v[238:239], s[70:71]
v_exp_f32 v48, v48
v_exp_f32 v49, v49
v_exp_f32 v50, v50
v_exp_f32 v51, v51
v_exp_f32 v52, v52
v_exp_f32 v53, v53
v_exp_f32 v54, v54
v_exp_f32 v55, v55
v_pk_add_f32 v[232:233], v[232:233], 1.0 op_sel_hi:[1,0]
v_pk_add_f32 v[234:235], v[234:235], 1.0 op_sel_hi:[1,0]
v_pk_add_f32 v[236:237], v[236:237], 1.0 op_sel_hi:[1,0]
v_pk_add_f32 v[238:239], v[238:239], 1.0 op_sel_hi:[1,0]
v_med3_f32 v232, v48, v232, 1.0
v_med3_f32 v233, v49, v233, 1.0
v_med3_f32 v234, v50, v234, 1.0
v_med3_f32 v235, v51, v235, 1.0
v_med3_f32 v236, v52, v236, 1.0
v_med3_f32 v237, v53, v237, 1.0
v_med3_f32 v238, v54, v238, 1.0
v_med3_f32 v239, v55, v239, 1.0
v_pk_add_f32 v[232:233], v[232:233], s[72:73]
v_pk_add_f32 v[234:235], v[234:235], s[72:73]
v_pk_add_f32 v[236:237], v[236:237], s[72:73]
v_pk_add_f32 v[238:239], v[238:239], s[72:73]
v_cvt_pk_bf16_f32 v32, v224, v225
v_cvt_pk_bf16_f32 v33, v226, v227
v_cvt_pk_bf16_f32 v34, v228, v229
v_cvt_pk_bf16_f32 v35, v230, v231
v_cvt_pk_bf16_f32 v36, v232, v233
v_cvt_pk_bf16_f32 v37, v234, v235
v_cvt_pk_bf16_f32 v38, v236, v237
v_cvt_pk_bf16_f32 v39, v238, v239
v_cndmask_b32 v38, v38, 0, s[60:61]
v_cndmask_b32 v39, v39, 0, s[60:61]
s_waitcnt vmcnt(6)
v_mfma_f32_32x32x16_bf16 v[16:31], v[104:107], v[112:115], 0
v_mfma_f32_32x32x16_bf16 v[16:31], v[104:107], v[116:119], v[16:31]
s_waitcnt vmcnt(4)
v_mfma_f32_32x32x16_bf16 v[16:31], v[104:107], v[120:123], v[16:31]
v_mfma_f32_32x32x16_bf16 v[16:31], v[104:107], v[124:127], v[16:31]
s_waitcnt vmcnt(2)
v_mfma_f32_32x32x16_bf16 v[16:31], v[104:107], v[128:131], v[16:31]
v_mfma_f32_32x32x16_bf16 v[16:31], v[104:107], v[132:135], v[16:31]
s_waitcnt vmcnt(0)
v_mfma_f32_32x32x16_bf16 v[16:31], v[104:107], v[136:139], v[16:31]
v_mfma_f32_32x32x16_bf16 v[16:31], v[104:107], v[140:143], v[16:31]
s_add_u32 m0, s67, 106496
s_nop 0
buffer_load_dwordx4 v3, s[40:43], s26 offen lds
s_add_u32 m0, s67, 114688
s_add_u32 s52, s26, 57344
buffer_load_dwordx4 v3, s[40:43], s52 offen lds
s_add_u32 m0, s67, 131072
s_add_u32 s52, s26, 172032
buffer_load_dwordx4 v3, s[40:43], s52 offen lds
s_nop 2
v_cvt_pk_bf16_f32 v24, v16, v17
v_cvt_pk_bf16_f32 v25, v18, v19
v_cvt_pk_bf16_f32 v26, v20, v21
v_cvt_pk_bf16_f32 v27, v22, v23
ds_write_b128 v252, v[24:27]
s_waitcnt lgkmcnt(0)
s_barrier
ds_read_b128 v[112:115], v253 offset:0
ds_read_b128 v[116:119], v253 offset:1024
ds_read_b128 v[120:123], v253 offset:2048
ds_read_b128 v[124:127], v253 offset:3072
s_add_u32 m0, s67, 0
s_nop 0
buffer_load_dwordx4 v3, s[44:47], s26 offen lds
s_add_u32 m0, s67, 8192
s_add_u32 s52, s26, 57344
buffer_load_dwordx4 v3, s[44:47], s52 offen lds
s_add_u32 m0, s67, 16384
s_add_u32 s52, s26, 114688
buffer_load_dwordx4 v3, s[44:47], s52 offen lds
s_waitcnt lgkmcnt(2)
v_mfma_f32_32x32x16_bf16 v[16:31], v[112:115], v[32:35], 0
v_mfma_f32_32x32x16_bf16 v[16:31], v[116:119], v[36:39], v[16:31]
s_waitcnt lgkmcnt(0)
v_mfma_f32_32x32x16_bf16 v[16:31], v[120:123], v[32:35], v[16:31]
v_mfma_f32_32x32x16_bf16 v[16:31], v[124:127], v[36:39], v[16:31]
s_nop 11
v_add_f32 v241, s72, v28
v_fma_f32 v241, v241, v240, v241
v_rcp_f32 v241, v241
s_nop 0
v_mov_b32 v242, v241
s_nop 1
v_permlane32_swap_b32 v241, v242
v_cndmask_b32 v28, v28, v23, s[60:61]
v_permlane32_swap_b32 v30, v31
v_permlane32_swap_b32 v29, v23
v_pk_mul_f32 v[16:17], v[16:17], v[242:243] op_sel_hi:[1,0]
v_pk_mul_f32 v[18:19], v[18:19], v[242:243] op_sel_hi:[1,0]
v_pk_mul_f32 v[20:21], v[20:21], v[242:243] op_sel_hi:[1,0]
v_pk_mul_f32 v[22:23], v[22:23], v[242:243] op_sel_hi:[1,0]
v_cvt_pk_bf16_f32 v232, v16, v17
v_cvt_pk_bf16_f32 v233, v18, v19
v_cvt_pk_bf16_f32 v234, v20, v21
v_cvt_pk_bf16_f32 v235, v22, v5
buffer_store_dwordx4 v[232:235], v2, s[32:35], s8 offen offset:0 sc1
v_pk_mul_f32 v[24:25], v[24:25], v[242:243] op_sel_hi:[1,0]
v_pk_mul_f32 v[26:27], v[26:27], v[242:243] op_sel_hi:[1,0]
v_pk_mul_f32 v[28:29], v[28:29], v[242:243] op_sel_hi:[1,0]
v_pk_mul_f32 v[30:31], v[30:31], v[242:243] op_sel_hi:[1,0]
v_cvt_pk_bf16_f32 v236, v24, v25
v_cvt_pk_bf16_f32 v237, v26, v27
v_cvt_pk_bf16_f32 v238, v28, v29
v_cvt_pk_bf16_f32 v239, v30, v5
buffer_store_dwordx4 v[236:239], v2, s[32:35], s8 offen offset:1024 sc1
buffer_store_dword v246, v254, s[32:35], s9 offen sc1
s_add_u32 m0, s67, 24576
s_add_u32 s52, s26, 172032
buffer_load_dwordx4 v3, s[44:47], s52 offen lds
s_add_u32 m0, s67, 32768
s_add_u32 s52, s26, 229376
buffer_load_dwordx4 v3, s[44:47], s52 offen lds
s_add_u32 m0, s67, 40960
s_add_u32 s52, s26, 286720
buffer_load_dwordx4 v3, s[44:47], s52 offen lds
s_add_u32 m0, s67, 49152
s_add_u32 s52, s26, 344064
buffer_load_dwordx4 v3, s[44:47], s52 offen lds
v_lshrrev_b32 v241, 5, v1
v_bfe_u32 v242, v1, 2, 2
v_lshl_add_u32 v243, v241, 2, v242
s_bfe_u32 s54, s37, 0x10007
s_mul_i32 s54, s54, 7168
s_mul_i32 s53, s57, 14336
s_add_u32 s53, s53, s54
s_add_u32 s53, s53, 106496
s_lshl_b32 s59, s54, 1
s_sub_u32 s59, s59, 7168
v_lshl_add_u32 v243, v243, 7, s53
v_and_b32 v242, 2, v242
v_lshlrev_b32 v242, 5, v242
v_and_b32 v244, 3, v1
v_lshlrev_b32 v244, 3, v244
v_and_b32 v92, 31, v1
v_mul_u32_u24 v92, 896, v92
v_lshl_add_u32 v92, v241, 4, v92
s_mov_b32 s60, 0
s_mov_b32 s61, -1
v_bfe_u32 v84, v1, 2, 2
v_mad_u32_u24 v85, v84, 6, 4
v_add_u32 v84, 13, v84
v_bfe_u32 v86, v1, 2, 1
v_add_u32 v86, -1, v86
v_and_b32 v85, v85, v86
v_cndmask_b32 v84, v84, v85, s[60:61]
v_cndmask_b32 v241, v242, 64, s[60:61]
v_lshl_add_u32 v84, v84, 7, s53
v_bfe_u32 v15, v1, 4, 1
v_add_u32 v15, 0, v15
v_xor_b32 v15, s57, v15
v_lshl_add_u32 v15, v15, 5, v244
v_xor_b32 v85, v15, v242
v_xor_b32 v15, v15, v241
v_add_u32 v80, v243, v85
v_add_u32 v82, v84, v15
v_bfe_u32 v15, v1, 4, 1
v_add_u32 v15, 2, v15
v_xor_b32 v15, s57, v15
v_lshl_add_u32 v15, v15, 5, v244
v_xor_b32 v85, v15, v242
v_xor_b32 v15, v15, v241
v_add_u32 v81, v243, v85
v_add_u32 v83, v84, v15
v_subrev_u32 v84, 106496, v80
v_subrev_u32 v85, 106496, v81
v_subrev_u32 v86, 106496, v82
v_subrev_u32 v87, 106496, v83
s_mul_i32 s53, s58, 24576
s_add_u32 s53, s53, 57344
s_xor_b32 s54, s57, 0
s_mul_i32 s54, s54, 6144
s_add_u32 s54, s54, s53
v_add_u32 v88, s54, v2
s_xor_b32 s54, s57, 1
s_mul_i32 s54, s54, 6144
s_add_u32 s54, s54, s53
v_add_u32 v89, s54, v2
s_xor_b32 s54, s57, 2
s_mul_i32 s54, s54, 6144
s_add_u32 s54, s54, s53
v_add_u32 v90, s54, v2
s_xor_b32 s54, s57, 3
s_mul_i32 s54, s54, 6144
s_add_u32 s54, s54, s53
v_add_u32 v91, s54, v2
s_waitcnt vmcnt(0)
s_load_dword s28, s[24:25], 0 glc
s_load_dword s29, s[24:25], 128 glc
s_load_dword s30, s[24:25], 256 glc
s_load_dword s31, s[24:25], 384 glc
s_barrier
L_p3:
ds_read_b64_tr_b16 v[94:95], v80 offset:0
ds_read_b64_tr_b16 v[98:99], v81 offset:0
ds_read_b64_tr_b16 v[96:97], v80 offset:1024
ds_read_b64_tr_b16 v[100:101], v81 offset:1024
ds_read_b64_tr_b16 v[102:103], v80 offset:2048
ds_read_b64_tr_b16 v[106:107], v81 offset:2048
ds_read_b64_tr_b16 v[104:105], v82 offset:1408
ds_read_b64_tr_b16 v[108:109], v83 offset:1408
s_waitcnt lgkmcnt(0)
s_xor_b32 s28, s28, s29
s_xor_b32 s30, s30, s31
s_xor_b32 s29, s29, s63
s_xor_b32 s31, s31, s63
s_or_b64 s[28:29], s[28:29], s[30:31]
s_cbranch_scc1 Lslow_20
buffer_load_dwordx4 v[48:51], v2, s[32:35], s16 offen offset:0 sc1
buffer_load_dwordx4 v[52:55], v2, s[32:35], s16 offen offset:1024 sc1
buffer_load_dwordx4 v[56:59], v2, s[32:35], s16 offen offset:2048 sc1
buffer_load_dwordx4 v[60:63], v2, s[32:35], s16 offen offset:3072 sc1
ds_read_b64_tr_b16 v[110:111], v80 offset:3584
ds_read_b64_tr_b16 v[114:115], v81 offset:3584
ds_read_b64_tr_b16 v[112:113], v80 offset:4608
ds_read_b64_tr_b16 v[116:117], v81 offset:4608
ds_read_b64_tr_b16 v[118:119], v80 offset:5632
ds_read_b64_tr_b16 v[122:123], v81 offset:5632
ds_read_b64_tr_b16 v[120:121], v82 offset:4992
ds_read_b64_tr_b16 v[124:125], v83 offset:4992
v_subrev_u32 v80, s59, v80
v_subrev_u32 v81, s59, v81
v_subrev_u32 v82, s59, v82
v_subrev_u32 v83, s59, v83
ds_read_b64_tr_b16 v[126:127], v80 offset:0
ds_read_b64_tr_b16 v[130:131], v81 offset:0
ds_read_b64_tr_b16 v[128:129], v80 offset:1024
ds_read_b64_tr_b16 v[132:133], v81 offset:1024
ds_read_b64_tr_b16 v[134:135], v80 offset:2048
ds_read_b64_tr_b16 v[138:139], v81 offset:2048
ds_read_b64_tr_b16 v[136:137], v82 offset:1408
ds_read_b64_tr_b16 v[140:141], v83 offset:1408
ds_read_b64_tr_b16 v[142:143], v80 offset:3584
ds_read_b64_tr_b16 v[146:147], v81 offset:3584
ds_read_b64_tr_b16 v[144:145], v80 offset:4608
ds_read_b64_tr_b16 v[148:149], v81 offset:4608
ds_read_b64_tr_b16 v[150:151], v80 offset:5632
ds_read_b64_tr_b16 v[154:155], v81 offset:5632
ds_read_b64_tr_b16 v[152:153], v82 offset:4992
ds_read_b64_tr_b16 v[156:157], v83 offset:4992
Lhave_21:
s_waitcnt lgkmcnt(0)
s_load_dword s28, s[20:21], 0 glc
s_load_dword s29, s[20:21], 128 glc
s_load_dword s30, s[20:21], 256 glc
s_load_dword s31, s[20:21], 384 glc
buffer_load_dwordx4 v[64:67], v2, s[32:35], s17 offen offset:0 sc1
buffer_load_dwordx4 v[68:71], v2, s[32:35], s17 offen offset:1024 sc1
buffer_load_dwordx4 v[72:75], v2, s[32:35], s17 offen offset:2048 sc1
buffer_load_dwordx4 v[76:79], v2, s[32:35], s17 offen offset:3072 sc1
s_waitcnt vmcnt(7)
v_mfma_f32_32x32x16_bf16 v[16:31], v[94:97], v[48:51], 0
v_mfma_f32_32x32x16_bf16 v[32:47], v[98:101], v[48:51], 0
v_xor_b32 v6, v51, v5
ds_read_b64_tr_b16 v[158:159], v84 offset:0
ds_read_b64_tr_b16 v[162:163], v85 offset:0
ds_read_b64_tr_b16 v[160:161], v84 offset:1024
ds_read_b64_tr_b16 v[164:165], v85 offset:1024
s_waitcnt vmcnt(6)
v_mfma_f32_32x32x16_bf16 v[16:31], v[102:105], v[52:55], v[16:31]
v_mfma_f32_32x32x16_bf16 v[32:47], v[106:109], v[52:55], v[32:47]
v_bitop3_b32 v6, v55, v5, v6 bitop3:0xbe
ds_read_b64_tr_b16 v[166:167], v84 offset:2048
ds_read_b64_tr_b16 v[170:171], v85 offset:2048
ds_read_b64_tr_b16 v[168:169], v86 offset:1408
ds_read_b64_tr_b16 v[172:173], v87 offset:1408
s_waitcnt vmcnt(5)
v_mfma_f32_32x32x16_bf16 v[16:31], v[110:113], v[56:59], v[16:31]
v_mfma_f32_32x32x16_bf16 v[32:47], v[114:117], v[56:59], v[32:47]
v_bitop3_b32 v6, v59, v5, v6 bitop3:0xbe
ds_read_b64_tr_b16 v[174:175], v84 offset:3584
ds_read_b64_tr_b16 v[178:179], v85 offset:3584
ds_read_b64_tr_b16 v[176:177], v84 offset:4608
ds_read_b64_tr_b16 v[180:181], v85 offset:4608
s_waitcnt vmcnt(4)
v_mfma_f32_32x32x16_bf16 v[16:31], v[118:121], v[60:63], v[16:31]
v_mfma_f32_32x32x16_bf16 v[32:47], v[122:125], v[60:63], v[32:47]
v_bitop3_b32 v6, v63, v5, v6 bitop3:0xbe
ds_read_b64_tr_b16 v[182:183], v84 offset:5632
ds_read_b64_tr_b16 v[186:187], v85 offset:5632
ds_read_b64_tr_b16 v[184:185], v86 offset:4992
ds_read_b64_tr_b16 v[188:189], v87 offset:4992
s_waitcnt lgkmcnt(0)
s_xor_b32 s28, s28, s29
s_xor_b32 s30, s30, s31
s_xor_b32 s29, s29, s63
s_xor_b32 s31, s31, s63
s_or_b64 s[28:29], s[28:29], s[30:31]
s_cbranch_scc1 Llate_22
buffer_load_dwordx4 v[222:225], v2, s[32:35], s18 offen offset:0 sc1
buffer_load_dwordx4 v[226:229], v2, s[32:35], s18 offen offset:1024 sc1
s_waitcnt vmcnt(5)
v_mfma_f32_32x32x16_bf16 v[16:31], v[126:129], v[64:67], v[16:31]
v_mfma_f32_32x32x16_bf16 v[32:47], v[130:133], v[64:67], v[32:47]
v_bitop3_b32 v6, v67, v5, v6 bitop3:0xbe
v_subrev_u32 v84, s59, v84
v_subrev_u32 v85, s59, v85
v_subrev_u32 v86, s59, v86
v_subrev_u32 v87, s59, v87
ds_read_b64_tr_b16 v[190:191], v84 offset:0
ds_read_b64_tr_b16 v[194:195], v85 offset:0
ds_read_b64_tr_b16 v[192:193], v84 offset:1024
ds_read_b64_tr_b16 v[196:197], v85 offset:1024
buffer_load_dwordx4 v[230:233], v2, s[32:35], s18 offen offset:2048 sc1
buffer_load_dwordx4 v[234:237], v2, s[32:35], s18 offen offset:3072 sc1
s_waitcnt vmcnt(6)
v_mfma_f32_32x32x16_bf16 v[16:31], v[134:137], v[68:71], v[16:31]
v_mfma_f32_32x32x16_bf16 v[32:47], v[138:141], v[68:71], v[32:47]
v_bitop3_b32 v6, v71, v5, v6 bitop3:0xbe
ds_read_b64_tr_b16 v[198:199], v84 offset:2048
ds_read_b64_tr_b16 v[202:203], v85 offset:2048
ds_read_b64_tr_b16 v[200:201], v86 offset:1408
ds_read_b64_tr_b16 v[204:205], v87 offset:1408
buffer_load_dwordx4 v[238:241], v2, s[32:35], s19 offen offset:0 sc1
buffer_load_dwordx4 v[242:245], v2, s[32:35], s19 offen offset:1024 sc1
s_waitcnt vmcnt(7)
v_mfma_f32_32x32x16_bf16 v[16:31], v[142:145], v[72:75], v[16:31]
v_mfma_f32_32x32x16_bf16 v[32:47], v[146:149], v[72:75], v[32:47]
v_bitop3_b32 v6, v75, v5, v6 bitop3:0xbe
ds_read_b64_tr_b16 v[206:207], v84 offset:3584
ds_read_b64_tr_b16 v[210:211], v85 offset:3584
ds_read_b64_tr_b16 v[208:209], v84 offset:4608
ds_read_b64_tr_b16 v[212:213], v85 offset:4608
buffer_load_dwordx4 v[246:249], v2, s[32:35], s19 offen offset:2048 sc1
buffer_load_dwordx4 v[250:253], v2, s[32:35], s19 offen offset:3072 sc1
s_waitcnt vmcnt(8)
v_mfma_f32_32x32x16_bf16 v[16:31], v[150:153], v[76:79], v[16:31]
v_mfma_f32_32x32x16_bf16 v[32:47], v[154:157], v[76:79], v[32:47]
v_bitop3_b32 v6, v79, v5, v6 bitop3:0xbe
ds_read_b64_tr_b16 v[214:215], v84 offset:5632
ds_read_b64_tr_b16 v[218:219], v85 offset:5632
ds_read_b64_tr_b16 v[216:217], v86 offset:4992
ds_read_b64_tr_b16 v[220:221], v87 offset:4992
Lpa_23:
s_waitcnt lgkmcnt(0)
s_waitcnt vmcnt(7)
v_mfma_f32_32x32x16_bf16 v[16:31], v[158:161], v[222:225], v[16:31]
v_mfma_f32_32x32x16_bf16 v[32:47], v[162:165], v[222:225], v[32:47]
v_bitop3_b32 v6, v225, v5, v6 bitop3:0xbe
s_waitcnt vmcnt(6)
v_mfma_f32_32x32x16_bf16 v[16:31], v[166:169], v[226:229], v[16:31]
v_mfma_f32_32x32x16_bf16 v[32:47], v[170:173], v[226:229], v[32:47]
v_bitop3_b32 v6, v229, v5, v6 bitop3:0xbe
s_waitcnt vmcnt(5)
v_mfma_f32_32x32x16_bf16 v[16:31], v[174:177], v[230:233], v[16:31]
v_mfma_f32_32x32x16_bf16 v[32:47], v[178:181], v[230:233], v[32:47]
v_bitop3_b32 v6, v233, v5, v6 bitop3:0xbe
s_waitcnt vmcnt(4)
v_mfma_f32_32x32x16_bf16 v[16:31], v[182:185], v[234:237], v[16:31]
v_mfma_f32_32x32x16_bf16 v[32:47], v[186:189], v[234:237], v[32:47]
v_bitop3_b32 v6, v237, v5, v6 bitop3:0xbe
s_waitcnt vmcnt(3)
v_mfma_f32_32x32x16_bf16 v[16:31], v[190:193], v[238:241], v[16:31]
v_mfma_f32_32x32x16_bf16 v[32:47], v[194:197], v[238:241], v[32:47]
v_bitop3_b32 v6, v241, v5, v6 bitop3:0xbe
s_waitcnt vmcnt(2)
v_mfma_f32_32x32x16_bf16 v[16:31], v[198:201], v[242:245], v[16:31]
v_mfma_f32_32x32x16_bf16 v[32:47], v[202:205], v[242:245], v[32:47]
v_bitop3_b32 v6, v245, v5, v6 bitop3:0xbe
s_waitcnt vmcnt(1)
v_mfma_f32_32x32x16_bf16 v[16:31], v[206:209], v[246:249], v[16:31]
v_mfma_f32_32x32x16_bf16 v[32:47], v[210:213], v[246:249], v[32:47]
v_bitop3_b32 v6, v249, v5, v6 bitop3:0xbe
s_waitcnt vmcnt(0)
v_mfma_f32_32x32x16_bf16 v[16:31], v[214:217], v[250:253], v[16:31]
v_mfma_f32_32x32x16_bf16 v[32:47], v[218:221], v[250:253], v[32:47]
v_bitop3_b32 v6, v253, v5, v6 bitop3:0xbe
v_cmp_lt_u32 vcc, 0xffff, v6
s_cbranch_vccnz Lredo_24
Lgood_25:
s_nop 7
ds_write_b128 v89, v[24:27] offset:0
ds_write_b128 v89, v[28:31] offset:1024
ds_write_b128 v90, v[32:35] offset:2048
ds_write_b128 v90, v[36:39] offset:3072
ds_write_b128 v91, v[40:43] offset:4096
ds_write_b128 v91, v[44:47] offset:5120
s_waitcnt lgkmcnt(0)
s_barrier
ds_read_b128 v[48:51], v88 offset:0
ds_read_b128 v[52:55], v88 offset:1024
ds_read_b128 v[56:59], v88 offset:2048
ds_read_b128 v[60:63], v88 offset:3072
ds_read_b128 v[64:67], v88 offset:4096
ds_read_b128 v[68:71], v88 offset:5120
s_waitcnt lgkmcnt(4)
v_pk_add_f32 v[16:17], v[16:17], v[48:49]
v_pk_add_f32 v[18:19], v[18:19], v[50:51]
v_pk_add_f32 v[20:21], v[20:21], v[52:53]
v_pk_add_f32 v[22:23], v[22:23], v[54:55]
s_waitcnt lgkmcnt(2)
v_pk_add_f32 v[16:17], v[16:17], v[56:57]
v_pk_add_f32 v[18:19], v[18:19], v[58:59]
v_pk_add_f32 v[20:21], v[20:21], v[60:61]
v_pk_add_f32 v[22:23], v[22:23], v[62:63]
s_waitcnt lgkmcnt(0)
v_pk_add_f32 v[16:17], v[16:17], v[64:65]
v_pk_add_f32 v[18:19], v[18:19], v[66:67]
v_pk_add_f32 v[20:21], v[20:21], v[68:69]
v_pk_add_f32 v[22:23], v[22:23], v[70:71]
v_cvt_pk_bf16_f32 v72, v16, v17
v_cvt_pk_bf16_f32 v73, v18, v19
v_cvt_pk_bf16_f32 v74, v20, v21
v_cvt_pk_bf16_f32 v75, v22, v23
s_nop 0
v_permlane32_swap_b32 v72, v74
v_permlane32_swap_b32 v73, v75
buffer_store_dwordx4 v[72:75], v92, s[48:51], s37 offen
L_done:
L_end:
s_endpgm
Lnon_5:
s_mov_b32 s69, 0
Lnonl_26:
global_load_dword v246, v247, s[20:21] sc1
s_add_u32 s69, s69, 1
s_cmp_gt_u32 s69, 65536
s_waitcnt vmcnt(0)
s_cbranch_scc1 Lnonb_6
v_cmp_eq_u32 vcc, 0, v246
s_cbranch_vccnz Lnonl_26
s_branch Lnonb_6
Lvp_7:
s_cmp_eq_u32 s15, 0
s_cbranch_scc1 Lvpb_8
s_mov_b32 s69, 0
Lvpl_27:
buffer_load_dword v249, v248, s[32:35], s12 offen sc1
s_add_u32 s69, s69, 1
s_cmp_gt_u32 s69, 65536
s_waitcnt vmcnt(0)
s_cbranch_scc1 Lvpb_8
v_cmp_ne_u32 vcc, v246, v249
s_cbranch_vccnz Lvpl_27
s_branch Lvpb_8
Lvp_9:
s_cmp_eq_u32 s15, 0
s_cbranch_scc1 Lvpb_10
s_mov_b32 s69, 0
Lvpl_28:
buffer_load_dword v250, v248, s[32:35], s12 offen sc1
s_add_u32 s69, s69, 1
s_cmp_gt_u32 s69, 65536
s_waitcnt vmcnt(0)
s_cbranch_scc1 Lvpb_10
v_cmp_ne_u32 vcc, v246, v250
s_cbranch_vccnz Lvpl_28
s_branch Lvpb_10
Lnon_15:
s_mov_b32 s69, 0
Lnonl_29:
global_load_dword v246, v247, s[20:21] sc1
s_add_u32 s69, s69, 1
s_cmp_gt_u32 s69, 65536
s_waitcnt vmcnt(0)
s_cbranch_scc1 Lnonb_16
v_cmp_eq_u32 vcc, 0, v246
s_cbranch_vccnz Lnonl_29
s_branch Lnonb_16
Lvp_18:
s_mov_b32 s69, 0
Lvpl_30:
buffer_load_dword v249, v248, s[32:35], s6 offen sc1
s_add_u32 s69, s69, 1
s_cmp_gt_u32 s69, 65536
s_waitcnt vmcnt(0)
s_cbranch_scc1 Lvpb_19
v_cmp_ne_u32 vcc, v246, v249
s_cbranch_vccnz Lvpl_30
s_branch Lvpb_19
Lslow_20:
s_load_dword s28, s[24:25], 0 glc
s_load_dword s29, s[24:25], 128 glc
s_load_dword s30, s[24:25], 256 glc
s_load_dword s31, s[24:25], 384 glc
ds_read_b64_tr_b16 v[110:111], v80 offset:3584
ds_read_b64_tr_b16 v[114:115], v81 offset:3584
ds_read_b64_tr_b16 v[112:113], v80 offset:4608
ds_read_b64_tr_b16 v[116:117], v81 offset:4608
ds_read_b64_tr_b16 v[118:119], v80 offset:5632
ds_read_b64_tr_b16 v[122:123], v81 offset:5632
ds_read_b64_tr_b16 v[120:121], v82 offset:4992
ds_read_b64_tr_b16 v[124:125], v83 offset:4992
v_subrev_u32 v80, s59, v80
v_subrev_u32 v81, s59, v81
v_subrev_u32 v82, s59, v82
v_subrev_u32 v83, s59, v83
ds_read_b64_tr_b16 v[126:127], v80 offset:0
ds_read_b64_tr_b16 v[130:131], v81 offset:0
ds_read_b64_tr_b16 v[128:129], v80 offset:1024
ds_read_b64_tr_b16 v[132:133], v81 offset:1024
ds_read_b64_tr_b16 v[134:135], v80 offset:2048
ds_read_b64_tr_b16 v[138:139], v81 offset:2048
ds_read_b64_tr_b16 v[136:137], v82 offset:1408
ds_read_b64_tr_b16 v[140:141], v83 offset:1408
ds_read_b64_tr_b16 v[142:143], v80 offset:3584
ds_read_b64_tr_b16 v[146:147], v81 offset:3584
ds_read_b64_tr_b16 v[144:145], v80 offset:4608
ds_read_b64_tr_b16 v[148:149], v81 offset:4608
ds_read_b64_tr_b16 v[150:151], v80 offset:5632
ds_read_b64_tr_b16 v[154:155], v81 offset:5632
ds_read_b64_tr_b16 v[152:153], v82 offset:4992
ds_read_b64_tr_b16 v[156:157], v83 offset:4992
s_waitcnt lgkmcnt(0)
s_xor_b32 s28, s28, s29
s_xor_b32 s30, s30, s31
s_xor_b32 s29, s29, s63
s_xor_b32 s31, s31, s63
s_or_b64 s[28:29], s[28:29], s[30:31]
s_cbranch_scc0 Lgot_31
s_mov_b32 s69, 0
Lpoll_32:
s_load_dword s28, s[24:25], 0 glc
s_load_dword s29, s[24:25], 128 glc
s_load_dword s30, s[24:25], 256 glc
s_load_dword s31, s[24:25], 384 glc
s_add_u32 s69, s69, 1
s_cmp_gt_u32 s69, 65536
s_waitcnt lgkmcnt(0)
s_cbranch_scc1 Lpolld_33
s_waitcnt lgkmcnt(0)
s_xor_b32 s28, s28, s29
s_xor_b32 s30, s30, s31
s_xor_b32 s29, s29, s63
s_xor_b32 s31, s31, s63
s_or_b64 s[28:29], s[28:29], s[30:31]
s_cbranch_scc1 Lpoll_32
Lpolld_33:
Lgot_31:
buffer_load_dwordx4 v[48:51], v2, s[32:35], s16 offen offset:0 sc1
buffer_load_dwordx4 v[52:55], v2, s[32:35], s16 offen offset:1024 sc1
buffer_load_dwordx4 v[56:59], v2, s[32:35], s16 offen offset:2048 sc1
buffer_load_dwordx4 v[60:63], v2, s[32:35], s16 offen offset:3072 sc1
s_branch Lhave_21
Llate_22:
s_load_dword s28, s[20:21], 0 glc
s_load_dword s29, s[20:21], 128 glc
s_load_dword s30, s[20:21], 256 glc
s_load_dword s31, s[20:21], 384 glc
s_waitcnt vmcnt(3)
v_mfma_f32_32x32x16_bf16 v[16:31], v[126:129], v[64:67], v[16:31]
v_mfma_f32_32x32x16_bf16 v[32:47], v[130:133], v[64:67], v[32:47]
v_bitop3_b32 v6, v67, v5, v6 bitop3:0xbe
v_subrev_u32 v84, s59, v84
v_subrev_u32 v85, s59, v85
v_subrev_u32 v86, s59, v86
v_subrev_u32 v87, s59, v87
ds_read_b64_tr_b16 v[190:191], v84 offset:0
ds_read_b64_tr_b16 v[194:195], v85 offset:0
ds_read_b64_tr_b16 v[192:193], v84 offset:1024
ds_read_b64_tr_b16 v[196:197], v85 offset:1024
s_waitcnt vmcnt(2)
v_mfma_f32_32x32x16_bf16 v[16:31], v[134:137], v[68:71], v[16:31]
v_mfma_f32_32x32x16_bf16 v[32:47], v[138:141], v[68:71], v[32:47]
v_bitop3_b32 v6, v71, v5, v6 bitop3:0xbe
ds_read_b64_tr_b16 v[198:199], v84 offset:2048
ds_read_b64_tr_b16 v[202:203], v85 offset:2048
ds_read_b64_tr_b16 v[200:201], v86 offset:1408
ds_read_b64_tr_b16 v[204:205], v87 offset:1408
s_waitcnt vmcnt(1)
v_mfma_f32_32x32x16_bf16 v[16:31], v[142:145], v[72:75], v[16:31]
v_mfma_f32_32x32x16_bf16 v[32:47], v[146:149], v[72:75], v[32:47]
v_bitop3_b32 v6, v75, v5, v6 bitop3:0xbe
ds_read_b64_tr_b16 v[206:207], v84 offset:3584
ds_read_b64_tr_b16 v[210:211], v85 offset:3584
ds_read_b64_tr_b16 v[208:209], v84 offset:4608
ds_read_b64_tr_b16 v[212:213], v85 offset:4608
s_waitcnt vmcnt(0)
v_mfma_f32_32x32x16_bf16 v[16:31], v[150:153], v[76:79], v[16:31]
v_mfma_f32_32x32x16_bf16 v[32:47], v[154:157], v[76:79], v[32:47]
v_bitop3_b32 v6, v79, v5, v6 bitop3:0xbe
ds_read_b64_tr_b16 v[214:215], v84 offset:5632
ds_read_b64_tr_b16 v[218:219], v85 offset:5632
ds_read_b64_tr_b16 v[216:217], v86 offset:4992
ds_read_b64_tr_b16 v[220:221], v87 offset:4992
s_waitcnt lgkmcnt(0)
s_xor_b32 s28, s28, s29
s_xor_b32 s30, s30, s31
s_xor_b32 s29, s29, s63
s_xor_b32 s31, s31, s63
s_or_b64 s[28:29], s[28:29], s[30:31]
s_cbranch_scc0 Lgot_34
s_mov_b32 s69, 0
Lpoll_35:
s_load_dword s28, s[20:21], 0 glc
s_load_dword s29, s[20:21], 128 glc
s_load_dword s30, s[20:21], 256 glc
s_load_dword s31, s[20:21], 384 glc
s_add_u32 s69, s69, 1
s_cmp_gt_u32 s69, 65536
s_waitcnt lgkmcnt(0)
s_cbranch_scc1 Lpolld_36
s_waitcnt lgkmcnt(0)
s_xor_b32 s28, s28, s29
s_xor_b32 s30, s30, s31
s_xor_b32 s29, s29, s63
s_xor_b32 s31, s31, s63
s_or_b64 s[28:29], s[28:29], s[30:31]
s_cbranch_scc1 Lpoll_35
Lpolld_36:
Lgot_34:
buffer_load_dwordx4 v[222:225], v2, s[32:35], s18 offen offset:0 sc1
buffer_load_dwordx4 v[226:229], v2, s[32:35], s18 offen offset:1024 sc1
buffer_load_dwordx4 v[230:233], v2, s[32:35], s18 offen offset:2048 sc1
buffer_load_dwordx4 v[234:237], v2, s[32:35], s18 offen offset:3072 sc1
buffer_load_dwordx4 v[238:241], v2, s[32:35], s19 offen offset:0 sc1
buffer_load_dwordx4 v[242:245], v2, s[32:35], s19 offen offset:1024 sc1
buffer_load_dwordx4 v[246:249], v2, s[32:35], s19 offen offset:2048 sc1
buffer_load_dwordx4 v[250:253], v2, s[32:35], s19 offen offset:3072 sc1
s_branch Lpa_23
Lredo_24:
s_mov_b32 s69, 0
Lredol_37:
buffer_load_dwordx4 v[48:51], v2, s[32:35], s16 offen offset:0 sc1
buffer_load_dwordx4 v[52:55], v2, s[32:35], s16 offen offset:1024 sc1
buffer_load_dwordx4 v[56:59], v2, s[32:35], s16 offen offset:2048 sc1
buffer_load_dwordx4 v[60:63], v2, s[32:35], s16 offen offset:3072 sc1
buffer_load_dwordx4 v[64:67], v2, s[32:35], s17 offen offset:0 sc1
buffer_load_dwordx4 v[68:71], v2, s[32:35], s17 offen offset:1024 sc1
buffer_load_dwordx4 v[72:75], v2, s[32:35], s17 offen offset:2048 sc1
buffer_load_dwordx4 v[76:79], v2, s[32:35], s17 offen offset:3072 sc1
buffer_load_dwordx4 v[222:225], v2, s[32:35], s18 offen offset:0 sc1
buffer_load_dwordx4 v[226:229], v2, s[32:35], s18 offen offset:1024 sc1
buffer_load_dwordx4 v[230:233], v2, s[32:35], s18 offen offset:2048 sc1
buffer_load_dwordx4 v[234:237], v2, s[32:35], s18 offen offset:3072 sc1
buffer_load_dwordx4 v[238:241], v2, s[32:35], s19 offen offset:0 sc1
buffer_load_dwordx4 v[242:245], v2, s[32:35], s19 offen offset:1024 sc1
buffer_load_dwordx4 v[246:249], v2, s[32:35], s19 offen offset:2048 sc1
buffer_load_dwordx4 v[250:253], v2, s[32:35], s19 offen offset:3072 sc1
s_add_u32 s69, s69, 1
s_waitcnt vmcnt(0)
v_mfma_f32_32x32x16_bf16 v[16:31], v[94:97], v[48:51], 0
v_mfma_f32_32x32x16_bf16 v[32:47], v[98:101], v[48:51], 0
v_xor_b32 v6, v51, v5
v_mfma_f32_32x32x16_bf16 v[16:31], v[102:105], v[52:55], v[16:31]
v_mfma_f32_32x32x16_bf16 v[32:47], v[106:109], v[52:55], v[32:47]
v_bitop3_b32 v6, v55, v5, v6 bitop3:0xbe
v_mfma_f32_32x32x16_bf16 v[16:31], v[110:113], v[56:59], v[16:31]
v_mfma_f32_32x32x16_bf16 v[32:47], v[114:117], v[56:59], v[32:47]
v_bitop3_b32 v6, v59, v5, v6 bitop3:0xbe
v_mfma_f32_32x32x16_bf16 v[16:31], v[118:121], v[60:63], v[16:31]
v_mfma_f32_32x32x16_bf16 v[32:47], v[122:125], v[60:63], v[32:47]
v_bitop3_b32 v6, v63, v5, v6 bitop3:0xbe
v_mfma_f32_32x32x16_bf16 v[16:31], v[126:129], v[64:67], v[16:31]
v_mfma_f32_32x32x16_bf16 v[32:47], v[130:133], v[64:67], v[32:47]
v_bitop3_b32 v6, v67, v5, v6 bitop3:0xbe
v_mfma_f32_32x32x16_bf16 v[16:31], v[134:137], v[68:71], v[16:31]
v_mfma_f32_32x32x16_bf16 v[32:47], v[138:141], v[68:71], v[32:47]
v_bitop3_b32 v6, v71, v5, v6 bitop3:0xbe
v_mfma_f32_32x32x16_bf16 v[16:31], v[142:145], v[72:75], v[16:31]
v_mfma_f32_32x32x16_bf16 v[32:47], v[146:149], v[72:75], v[32:47]
v_bitop3_b32 v6, v75, v5, v6 bitop3:0xbe
v_mfma_f32_32x32x16_bf16 v[16:31], v[150:153], v[76:79], v[16:31]
v_mfma_f32_32x32x16_bf16 v[32:47], v[154:157], v[76:79], v[32:47]
v_bitop3_b32 v6, v79, v5, v6 bitop3:0xbe
v_mfma_f32_32x32x16_bf16 v[16:31], v[158:161], v[222:225], v[16:31]
v_mfma_f32_32x32x16_bf16 v[32:47], v[162:165], v[222:225], v[32:47]
v_bitop3_b32 v6, v225, v5, v6 bitop3:0xbe
v_mfma_f32_32x32x16_bf16 v[16:31], v[166:169], v[226:229], v[16:31]
v_mfma_f32_32x32x16_bf16 v[32:47], v[170:173], v[226:229], v[32:47]
v_bitop3_b32 v6, v229, v5, v6 bitop3:0xbe
v_mfma_f32_32x32x16_bf16 v[16:31], v[174:177], v[230:233], v[16:31]
v_mfma_f32_32x32x16_bf16 v[32:47], v[178:181], v[230:233], v[32:47]
v_bitop3_b32 v6, v233, v5, v6 bitop3:0xbe
v_mfma_f32_32x32x16_bf16 v[16:31], v[182:185], v[234:237], v[16:31]
v_mfma_f32_32x32x16_bf16 v[32:47], v[186:189], v[234:237], v[32:47]
v_bitop3_b32 v6, v237, v5, v6 bitop3:0xbe
v_mfma_f32_32x32x16_bf16 v[16:31], v[190:193], v[238:241], v[16:31]
v_mfma_f32_32x32x16_bf16 v[32:47], v[194:197], v[238:241], v[32:47]
v_bitop3_b32 v6, v241, v5, v6 bitop3:0xbe
v_mfma_f32_32x32x16_bf16 v[16:31], v[198:201], v[242:245], v[16:31]
v_mfma_f32_32x32x16_bf16 v[32:47], v[202:205], v[242:245], v[32:47]
v_bitop3_b32 v6, v245, v5, v6 bitop3:0xbe
v_mfma_f32_32x32x16_bf16 v[16:31], v[206:209], v[246:249], v[16:31]
v_mfma_f32_32x32x16_bf16 v[32:47], v[210:213], v[246:249], v[32:47]
v_bitop3_b32 v6, v249, v5, v6 bitop3:0xbe
v_mfma_f32_32x32x16_bf16 v[16:31], v[214:217], v[250:253], v[16:31]
v_mfma_f32_32x32x16_bf16 v[32:47], v[218:221], v[250:253], v[32:47]
v_bitop3_b32 v6, v253, v5, v6 bitop3:0xbe
s_cmp_gt_u32 s69, 65536
s_cbranch_scc1 Lgood_25
v_cmp_lt_u32 vcc, 0xffff, v6
s_cbranch_vccnz Lredol_37
s_branch Lgood_25
L_code_end:
.section .rodata,"a"
.p2align 6
.amdhsa_kernel gated_mix__sliding_block__linear_attn_block__prompt_kernel
  .amdhsa_next_free_vgpr 256
  .amdhsa_next_free_sgpr 102
  .amdhsa_accum_offset 256
  .amdhsa_group_segment_fixed_size 0
  .amdhsa_kernarg_size 80
  .amdhsa_user_sgpr_count 2
  .amdhsa_user_sgpr_kernarg_segment_ptr 1
  .amdhsa_system_sgpr_workgroup_id_x 1
.end_amdhsa_kernel
```
